```python
import torch

def _softmax(x, axis=-1):
    return torch.softmax(x, dim=axis)
def _gelu(x):
    return torch.nn.functional.gelu(x, approximate="tanh")
def _silu(x):
    return torch.nn.functional.silu(x)
def _sigmoid(x):
    return torch.sigmoid(x)
def _layernorm(x, axis=-1, eps=1e-5):
    m = x.mean(dim=axis, keepdim=True)
    v = x.var(dim=axis, keepdim=True, unbiased=False)
    return (x - m) / torch.sqrt(v + eps)
def _scatter_add(tgt, idx, src, axis=0):
    return tgt.clone().index_add_(axis, idx, src)
def _segment_sum(src, seg, n):
    out = torch.zeros((n,) + src.shape[1:], dtype=src.dtype)
    return out.index_add_(0, seg, src)
def _pad(x, pw):
    flat = tuple(v for pair in reversed(pw) for v in pair)
    return torch.nn.functional.pad(x, flat)

kernel_name = 'sequential_preLN__linear_attn_block__mixer_channel_mlp__prompt'

def setup_inputs():

    _w = (lambda a: (lambda t: t.to(torch.bfloat16) if t.is_floating_point() else t)(torch.as_tensor(a)))
    def _A_setup():
        B, S, D = 1, 2048, 512
        return {
            "x": _w((lambda *s: torch.randn(*s, dtype=torch.bfloat16) * 0.05)(B, S, D)),
            "wqkv": _w((lambda *s: torch.randn(*s, dtype=torch.bfloat16) * 0.1)(D, 3 * D)),
            "wo": _w((lambda *s: torch.randn(*s, dtype=torch.bfloat16) * 0.05)(D, D)),
        }
    _A_in = _A_setup()

    def _B_setup():
        B, S, D, F = 1, 2048, 512, 1792
        return {
            "x": _w((lambda *s: torch.randn(*s, dtype=torch.bfloat16) * 0.05)(B, S, D)),
            "w1": _w((lambda *s: torch.randn(*s, dtype=torch.bfloat16) * 3.2)(D, F) * (D ** -0.5)),
            "b1": _w((lambda *s: torch.randn(*s, dtype=torch.bfloat16) * 0.8)(F)),
            "w2": _w((lambda *s: torch.randn(*s, dtype=torch.bfloat16) * 0.05)(F, D) * (F ** -0.5)),
            "b2": _w((lambda *s: torch.randn(*s, dtype=torch.bfloat16) * 0.05)(D)),
        }
    _B_in = _B_setup()

    return {
        "A_x": _A_in["x"],
        "A_wqkv": _A_in["wqkv"],
        "A_wo": _A_in["wo"],
        "B_x": _B_in["x"],
        "B_w1": _B_in["w1"],
        "B_b1": _B_in["b1"],
        "B_w2": _B_in["w2"],
        "B_b2": _B_in["b2"],
    }

def reference(A_x, A_wqkv, A_wo, B_x, B_w1, B_b1, B_w2, B_b2):
    def _A_ref(x, wqkv, wo):
        B, S, D = x.shape
        H = 32; Dh = D // H
        qkv = (lambda x, *d: x.permute(*d))((x @ wqkv).reshape(B, S, 3, H, Dh), 2, 0, 3, 1, 4)
        q, k, v = qkv[0], qkv[1], qkv[2]
        phi = lambda t: torch.where(t > 0, t + 1, torch.exp(t)) + 1e-6
        pq, pk = phi(q), phi(k)
        kv = torch.einsum("bhsd,bhse->bhde", pk, v)
        z = torch.einsum("bhsd->bhd", pk)
        num = torch.einsum("bhqd,bhde->bhqe", pq, kv)
        den = torch.einsum("bhqd,bhd->bhq", pq, z)[..., None] + 1e-6
        o = num / den
        return (lambda x, *d: x.permute(*d))(o, 0, 2, 1, 3).reshape(B, S, D) @ wo

    def _B_ref(x, w1, b1, w2, b2):
        y = _layernorm(x, axis=-1)
        h = _gelu(torch.einsum("bsd,df->bsf", y, w1) + b1)
        return torch.einsum("bsf,fd->bsd", h, w2) + b2

    x = A_x
    h = x + _A_ref(_layernorm(x, axis=-1), A_wqkv, A_wo)
    h2 = h + _B_ref(_layernorm(h, axis=-1), B_w1, B_b1, B_w2, B_b2)
    return h2
```

```asm
; @launch kernel=fused_kernel grid=(256,1,1) block=(768,1,1) lds=163840
.amdgcn_target "amdgcn-amd-amdhsa--gfx950"
.text
.globl fused_kernel
.p2align 8
.type fused_kernel,@function
fused_kernel:
    s_cmp_ge_u32 s2, 256
    s_cbranch_scc1 fused_kernel_done
    s_load_dwordx2 s[4:5], s[0:1], 0
    s_load_dwordx2 s[8:9], s[0:1], 8
    s_load_dwordx2 s[12:13], s[0:1], 16
    s_load_dwordx2 s[16:17], s[0:1], 32
    s_load_dwordx2 s[20:21], s[0:1], 40
    s_load_dwordx2 s[24:25], s[0:1], 48
    s_load_dwordx2 s[28:29], s[0:1], 56
    s_load_dwordx2 s[32:33], s[0:1], 64
    s_load_dwordx2 s[36:37], s[0:1], 72
    s_load_dwordx2 s[40:41], s[0:1], 80
    s_mov_b32 s6, 0x200000
    s_mov_b32 s7, 0x20000
    s_mov_b32 s10, 0x180000
    s_mov_b32 s11, 0x20000
    s_mov_b32 s14, 0x80000
    s_mov_b32 s15, 0x20000
    s_mov_b32 s18, 0x1c0000
    s_mov_b32 s19, 0x20000
    s_mov_b32 s22, 0xe00
    s_mov_b32 s23, 0x20000
    s_mov_b32 s26, 0x1c0000
    s_mov_b32 s27, 0x20000
    s_mov_b32 s30, 0x400
    s_mov_b32 s31, 0x20000
    s_mov_b32 s34, 0x200000
    s_mov_b32 s35, 0x20000
    s_mov_b32 s38, 0x100
    s_mov_b32 s39, 0x20000
    s_mov_b32 s42, 0x2000000
    s_mov_b32 s43, 0x20000
    v_lshrrev_b32 v5, 6, v0
    s_nop 0
    v_readfirstlane_b32 s44, v5
    s_and_b32 s45, s2, 7
    s_lshr_b32 s46, s2, 3
    v_and_b32 v1, 63, v0
    v_bfe_u32 v2, v0, 4, 2
    v_lshlrev_b32 v3, 4, v1
    s_and_b32 s55, s46, 1
    s_lshr_b32 s56, s46, 1
    s_lshr_b32 s59, s46, 2
    s_mov_b32 s47, 0
    s_mov_b32 s48, 0
    s_mul_i32 s72, s45, 0x1c0000
    s_mul_i32 s73, s45, 0x120000
    s_add_u32 s73, s73, 0x40000
    s_getreg_b32 s49, hwreg(HW_REG_XCC_ID)
    s_and_b32 s49, s49, 15
    s_cmp_lg_u32 s49, s45
    s_cselect_b32 s49, 1, 0
    s_cmp_ge_u32 s44, 8
    s_cbranch_scc1 fused_kernel_helper
    v_lshlrev_b32 v4, 3, v0
    v_add_u32 v45, 0x10000, v3
    v_add_u32 v46, 0x20000, v3
    s_mov_b32 s54, 0x3f803f80
    s_lshl_b32 s57, s45, 4
    s_lshl_b32 s50, s55, 3
    s_add_u32 s57, s57, s50
    s_add_u32 s57, s57, s44
    s_lshr_b32 s60, s44, 2
    s_and_b32 s61, s44, 3
    s_and_b32 s50, s46, 3
    s_lshl_b32 s50, s50, 2
    s_lshl_b32 s58, s45, 4
    s_add_u32 s58, s58, s50
    s_add_u32 s58, s58, s61
    s_sub_u32 s50, s58, s61
    s_lshl_b32 s50, s50, 14
    s_lshl_b32 s52, s59, 7
    s_add_u32 s50, s50, s52
    v_lshrrev_b32 v5, 3, v0
    v_lshlrev_b32 v9, 10, v5
    v_and_b32 v5, 7, v0
    v_lshl_add_u32 v9, v5, 4, v9
    v_add_u32 v9, s50, v9
    s_waitcnt lgkmcnt(0)
    s_and_b32 s5, s5, 0xffff
    s_and_b32 s9, s9, 0xffff
    s_and_b32 s13, s13, 0xffff
    s_and_b32 s17, s17, 0xffff
    s_and_b32 s21, s21, 0xffff
    s_and_b32 s25, s25, 0xffff
    s_and_b32 s29, s29, 0xffff
    s_and_b32 s33, s33, 0xffff
    s_and_b32 s37, s37, 0xffff
    s_and_b32 s41, s41, 0xffff
    s_cmp_lg_u32 s49, 0
    s_cbranch_scc1 fused_kernel_cfallback
fused_kernel_cstart:
    v_mov_b32 v10, 0x3f803f80
    v_mov_b32 v11, 0x3f803f80
    s_cmp_ge_u32 s46, 16
    s_cbranch_scc1 fused_kernel_p0a1
    v_lshrrev_b32 v5, 5, v1
    v_and_b32 v6, 31, v1
    v_lshlrev_b32 v7, 10, v5
    v_lshl_add_u32 v7, v6, 4, v7
    s_lshl_b32 s50, s45, 4
    s_add_u32 s50, s50, s46
    s_lshl_b32 s50, s50, 14
    s_lshl_b32 s51, s44, 11
    s_add_u32 s50, s50, s51
    buffer_load_dwordx4 v[104:107], v7, s[4:7], s50 offen
    buffer_load_dwordx4 v[108:111], v7, s[4:7], s50 offen offset:512
fused_kernel_p0a1:
    s_lshl_b32 s51, s46, 3
    s_add_u32 s51, s51, s44
    s_mul_i32 s52, s51, 24
    s_mul_i32 s51, s51, 40
    s_sub_u32 s51, s51, 2048
    s_cmp_lt_u32 s46, 16
    s_cselect_b32 s52, s52, s51
    s_cselect_b32 exec_lo, 0xffffff, 0xffffffff
    s_cselect_b32 exec_hi, 0x0, 0xff
    v_add_u32 v40, s52, v1
    v_lshrrev_b32 v41, 4, v40
    v_mul_u32_u24 v41, 0xc00, v41
    v_and_b32 v40, 15, v40
    v_lshl_add_u32 v40, v40, 7, v41
    buffer_load_dword v41, v40, s[8:11], 0 offen offset:1024
    s_mov_b64 exec, -1
    s_cmp_ge_u32 s46, 16
    s_cbranch_scc1 fused_kernel_p0a2
    v_lshrrev_b32 v7, 2, v6
    v_mul_u32_u24 v7, 1040, v7
    v_and_b32 v8, 3, v6
    v_lshl_add_u32 v7, v8, 8, v7
    s_lshl_b32 s51, s44, 1
    v_add_u32 v5, s51, v5
    v_lshl_add_u32 v5, v8, 2, v5
    v_and_b32 v5, 15, v5
    v_lshl_add_u32 v7, v5, 4, v7
    v_add_u32 v7, 0x18000, v7
    s_mul_i32 s51, s44, 2080
    s_add_u32 s51, s51, 98304
    v_lshl_add_u32 v8, v2, 2, v1
    v_and_b32 v8, 15, v8
    v_lshlrev_b32 v8, 4, v8
    v_lshl_add_u32 v8, v2, 8, v8
    v_add_u32 v8, s51, v8
    s_waitcnt vmcnt(1)
    v_dot2_f32_bf16 v112, v104, s54, 0
    v_dot2_f32_bf16 v113, v105, s54, 0
    v_dot2_f32_bf16 v114, v104, v104, 0
    v_dot2_f32_bf16 v115, v105, v105, 0
    v_dot2_f32_bf16 v112, v106, s54, v112
    v_dot2_f32_bf16 v113, v107, s54, v113
    v_dot2_f32_bf16 v114, v106, v106, v114
    v_dot2_f32_bf16 v115, v107, v107, v115
    v_dot2_f32_bf16 v112, v108, s54, v112
    v_dot2_f32_bf16 v113, v109, s54, v113
    v_dot2_f32_bf16 v114, v108, v108, v114
    v_dot2_f32_bf16 v115, v109, v109, v115
    v_dot2_f32_bf16 v112, v110, s54, v112
    v_dot2_f32_bf16 v113, v111, s54, v113
    v_dot2_f32_bf16 v114, v110, v110, v114
    v_dot2_f32_bf16 v115, v111, v111, v115
    v_lshlrev_b32 v120, 16, v104
    v_and_b32 v121, 0xffff0000, v104
    v_lshlrev_b32 v122, 16, v105
    v_and_b32 v123, 0xffff0000, v105
    v_lshlrev_b32 v124, 16, v106
    v_and_b32 v125, 0xffff0000, v106
    v_lshlrev_b32 v126, 16, v107
    v_and_b32 v127, 0xffff0000, v107
    v_lshlrev_b32 v128, 16, v108
    v_and_b32 v129, 0xffff0000, v108
    v_lshlrev_b32 v130, 16, v109
    v_and_b32 v131, 0xffff0000, v109
    v_lshlrev_b32 v132, 16, v110
    v_and_b32 v133, 0xffff0000, v110
    v_lshlrev_b32 v134, 16, v111
    v_and_b32 v135, 0xffff0000, v111
    v_add_f32 v112, v112, v113
    v_add_f32 v114, v114, v115
    s_nop 0
    v_add_f32_dpp v112, v112, v112 quad_perm:[1,0,3,2] row_mask:0xf bank_mask:0xf
    v_add_f32_dpp v114, v114, v114 quad_perm:[1,0,3,2] row_mask:0xf bank_mask:0xf
    s_nop 0
    v_add_f32_dpp v112, v112, v112 quad_perm:[2,3,0,1] row_mask:0xf bank_mask:0xf
    v_add_f32_dpp v114, v114, v114 quad_perm:[2,3,0,1] row_mask:0xf bank_mask:0xf
    s_nop 0
    v_add_f32_dpp v112, v112, v112 row_half_mirror row_mask:0xf bank_mask:0xf
    v_add_f32_dpp v114, v114, v114 row_half_mirror row_mask:0xf bank_mask:0xf
    s_nop 0
    v_add_f32_dpp v112, v112, v112 row_mirror row_mask:0xf bank_mask:0xf
    v_add_f32_dpp v114, v114, v114 row_mirror row_mask:0xf bank_mask:0xf
    v_mov_b32 v113, v112
    v_mov_b32 v115, v114
    s_nop 0
    v_permlane16_swap_b32 v112, v113
    v_permlane16_swap_b32 v114, v115
    v_add_f32 v112, v112, v113
    v_add_f32 v114, v114, v115
    v_mul_f32 v112, 0x3b000000, v112
    v_mul_f32 v114, 0x3b000000, v114
    v_cvt_pk_bf16_f32 v117, 0, v112
    v_mul_f32 v116, v112, v112
    v_sub_f32 v118, 0, v117
    v_sub_f32 v119, 0, v117
    v_sub_f32 v114, v114, v116
    v_max_f32 v114, 0, v114
    v_cvt_pk_bf16_f32 v114, 0, v114
    v_pk_add_f32 v[120:121], v[120:121], v[118:119]
    v_pk_add_f32 v[122:123], v[122:123], v[118:119]
    v_pk_add_f32 v[124:125], v[124:125], v[118:119]
    v_pk_add_f32 v[126:127], v[126:127], v[118:119]
    v_pk_add_f32 v[128:129], v[128:129], v[118:119]
    v_pk_add_f32 v[130:131], v[130:131], v[118:119]
    v_pk_add_f32 v[132:133], v[132:133], v[118:119]
    v_pk_add_f32 v[134:135], v[134:135], v[118:119]
    v_add_f32 v114, 0x3727c5ac, v114
    v_cvt_pk_bf16_f32 v114, 0, v114
    v_sqrt_f32 v114, v114
    v_cvt_pk_bf16_f32 v120, 0, v120
    v_cvt_pk_bf16_f32 v121, 0, v121
    v_cvt_pk_bf16_f32 v122, 0, v122
    v_cvt_pk_bf16_f32 v123, 0, v123
    v_cvt_pk_bf16_f32 v124, 0, v124
    v_cvt_pk_bf16_f32 v125, 0, v125
    v_cvt_pk_bf16_f32 v126, 0, v126
    v_cvt_pk_bf16_f32 v127, 0, v127
    v_cvt_pk_bf16_f32 v114, 0, v114
    v_rcp_f32 v118, v114
    v_rcp_f32 v119, v114
    v_cvt_pk_bf16_f32 v128, 0, v128
    v_cvt_pk_bf16_f32 v129, 0, v129
    v_cvt_pk_bf16_f32 v130, 0, v130
    v_cvt_pk_bf16_f32 v131, 0, v131
    v_cvt_pk_bf16_f32 v132, 0, v132
    v_cvt_pk_bf16_f32 v133, 0, v133
    v_cvt_pk_bf16_f32 v134, 0, v134
    v_cvt_pk_bf16_f32 v135, 0, v135
    v_pk_mul_f32 v[120:121], v[120:121], v[118:119]
    v_pk_mul_f32 v[122:123], v[122:123], v[118:119]
    v_pk_mul_f32 v[124:125], v[124:125], v[118:119]
    v_pk_mul_f32 v[126:127], v[126:127], v[118:119]
    v_pk_mul_f32 v[128:129], v[128:129], v[118:119]
    v_pk_mul_f32 v[130:131], v[130:131], v[118:119]
    v_pk_mul_f32 v[132:133], v[132:133], v[118:119]
    v_pk_mul_f32 v[134:135], v[134:135], v[118:119]
    v_cvt_pk_bf16_f32 v104, v120, v121
    v_cvt_pk_bf16_f32 v105, v122, v123
    v_cvt_pk_bf16_f32 v106, v124, v125
    v_cvt_pk_bf16_f32 v107, v126, v127
    v_cvt_pk_bf16_f32 v108, v128, v129
    v_cvt_pk_bf16_f32 v109, v130, v131
    v_cvt_pk_bf16_f32 v110, v132, v133
    v_cvt_pk_bf16_f32 v111, v134, v135
    ds_write_b128 v7, v[104:107]
    ds_write_b128 v7, v[108:111] offset:8320
    s_waitcnt lgkmcnt(0)
fused_kernel_p0a2:
    s_barrier
    s_cmp_ge_u32 s46, 16
    s_cbranch_scc1 fused_kernel_p0b3
    ds_read_b128 v[104:107], v8
    ds_read_b128 v[108:111], v8 offset:1040
    s_add_u32 s50, s50, s72
    s_waitcnt lgkmcnt(0)
    buffer_store_dwordx4 v[104:107], v3, s[40:43], s50 offen sc1
    buffer_store_dwordx4 v[108:111], v3, s[40:43], s50 offen offset:1024 sc1
fused_kernel_p0b3:
    v_bfe_u32 v5, v1, 2, 2
    v_and_b32 v7, 1, v2
    v_lshl_add_u32 v5, v7, 3, v5
    v_lshlrev_b32 v5, 6, v5
    v_and_b32 v6, 1, v1
    v_lshl_add_u32 v5, v6, 3, v5
    v_bfe_u32 v6, v1, 1, 1
    v_lshlrev_b32 v7, 1, v7
    v_xor_b32 v6, v6, v7
    v_lshrrev_b32 v8, 1, v2
    v_lshl_add_u32 v7, v6, 4, v5
    v_lshl_add_u32 v24, v8, 10, v7
    v_add_u32 v26, 0x10000, v24
    v_xor_b32 v6, 2, v6
    v_lshl_add_u32 v7, v6, 4, v5
    v_lshl_add_u32 v25, v8, 10, v7
    v_add_u32 v27, 0x10000, v25
    v_lshrrev_b32 v5, 2, v1
    v_and_b32 v6, 3, v1
    v_lshrrev_b32 v7, 3, v5
    v_lshlrev_b32 v7, 1, v7
    v_xor_b32 v6, v6, v7
    v_mul_u32_u24 v30, 0xc00, v5
    v_lshl_add_u32 v30, v6, 4, v30
    s_lshl_b32 s50, s56, 6
    v_add_u32 v30, s50, v30
    s_mul_i32 s50, s44, 98304
    s_lshl_b32 s51, s44, 11
    v_mov_b32 v32, v24
    v_mov_b32 v33, v25
    v_add_u32 v24, s51, v24
    v_add_u32 v25, s51, v25
    v_add_u32 v26, s51, v26
    v_add_u32 v27, s51, v27
    v_add_u32 v28, s51, v3
    v_add_u32 v29, s51, v45
    s_waitcnt vmcnt(0)
    s_barrier
    s_barrier
    s_add_u32 s52, s50, 0x400
    s_add_u32 m0, s51, 0x8000
    s_nop 0
    buffer_load_dwordx4 v30, s[8:11], s52 offen lds
    s_add_u32 s52, s50, 0xc400
    s_add_u32 m0, s51, 0x8400
    s_nop 0
    buffer_load_dwordx4 v30, s[8:11], s52 offen lds
    s_add_u32 s52, s50, 0xc0400
    s_add_u32 m0, s51, 0xc000
    s_nop 0
    buffer_load_dwordx4 v30, s[8:11], s52 offen lds
    s_add_u32 s52, s50, 0xcc400
    s_add_u32 m0, s51, 0xc400
    s_nop 0
    buffer_load_dwordx4 v30, s[8:11], s52 offen lds
    s_add_u32 s52, s50, 0x800
    s_add_u32 m0, s51, 0x10000
    s_nop 0
    buffer_load_dwordx4 v30, s[8:11], s52 offen lds
    s_add_u32 s52, s50, 0xc800
    s_add_u32 m0, s51, 0x10400
    s_nop 0
    buffer_load_dwordx4 v30, s[8:11], s52 offen lds
    s_add_u32 s52, s50, 0xc0800
    s_add_u32 m0, s51, 0x14000
    s_nop 0
    buffer_load_dwordx4 v30, s[8:11], s52 offen lds
    s_add_u32 s52, s50, 0xcc800
    s_add_u32 m0, s51, 0x14400
    s_nop 0
    buffer_load_dwordx4 v30, s[8:11], s52 offen lds
    s_barrier
    buffer_load_dwordx4 v[20:23], v9, s[4:7], 0 offen
    s_mul_i32 s52, s56, 224
    v_lshlrev_b32 v36, 3, v1
    v_add_u32 v36, s52, v36
    buffer_load_dwordx2 v[36:37], v36, s[20:23], 0 offen
    s_lshl_b32 s50, s57, 14
    s_add_u32 s50, s50, s72
    s_waitcnt vmcnt(2)
    ds_read_b64_tr_b16 v[104:105], v24 offset:32768
    ds_read_b64_tr_b16 v[106:107], v24 offset:33024
    ds_read_b64_tr_b16 v[108:109], v25 offset:32768
    ds_read_b64_tr_b16 v[110:111], v25 offset:33024
    ds_read_b64_tr_b16 v[112:113], v24 offset:49152
    ds_read_b64_tr_b16 v[114:115], v24 offset:49408
    ds_read_b64_tr_b16 v[116:117], v25 offset:49152
    ds_read_b64_tr_b16 v[118:119], v25 offset:49408
    ds_read_b64_tr_b16 v[120:121], v26 offset:0
    ds_read_b64_tr_b16 v[122:123], v26 offset:256
    ds_read_b64_tr_b16 v[124:125], v27 offset:0
    ds_read_b64_tr_b16 v[126:127], v27 offset:256
    ds_read_b64_tr_b16 v[128:129], v26 offset:16384
    ds_read_b64_tr_b16 v[130:131], v26 offset:16640
    ds_read_b64_tr_b16 v[132:133], v27 offset:16384
    ds_read_b64_tr_b16 v[134:135], v27 offset:16640
    s_waitcnt lgkmcnt(0)
    ds_write_b128 v28, v[104:107] offset:32768
    ds_write_b128 v28, v[108:111] offset:33792
    ds_write_b128 v28, v[112:115] offset:49152
    ds_write_b128 v28, v[116:119] offset:50176
    ds_write_b128 v29, v[120:123] offset:0
    ds_write_b128 v29, v[124:127] offset:1024
    ds_write_b128 v29, v[128:131] offset:16384
    ds_write_b128 v29, v[132:135] offset:17408
    s_waitcnt lgkmcnt(0)
    s_barrier
    buffer_load_dwordx4 v[104:107], v3, s[40:43], s50 offen sc1
    buffer_load_dwordx4 v[108:111], v3, s[40:43], s50 offen offset:1024 sc1
    buffer_load_dwordx4 v[112:115], v3, s[40:43], s50 offen offset:2048 sc1
    buffer_load_dwordx4 v[116:119], v3, s[40:43], s50 offen offset:3072 sc1
    s_add_u32 s50, s50, 4096
    buffer_load_dwordx4 v[120:123], v3, s[40:43], s50 offen sc1
    buffer_load_dwordx4 v[124:127], v3, s[40:43], s50 offen offset:1024 sc1
    buffer_load_dwordx4 v[128:131], v3, s[40:43], s50 offen offset:2048 sc1
    buffer_load_dwordx4 v[132:135], v3, s[40:43], s50 offen offset:3072 sc1
    s_add_u32 s50, s50, 4096
    buffer_load_dwordx4 v[136:139], v3, s[40:43], s50 offen sc1
    buffer_load_dwordx4 v[140:143], v3, s[40:43], s50 offen offset:1024 sc1
    buffer_load_dwordx4 v[144:147], v3, s[40:43], s50 offen offset:2048 sc1
    buffer_load_dwordx4 v[148:151], v3, s[40:43], s50 offen offset:3072 sc1
    s_add_u32 s50, s50, 4096
    buffer_load_dwordx4 v[152:155], v3, s[40:43], s50 offen sc1
    buffer_load_dwordx4 v[156:159], v3, s[40:43], s50 offen offset:1024 sc1
    buffer_load_dwordx4 v[160:163], v3, s[40:43], s50 offen offset:2048 sc1
    buffer_load_dwordx4 v[164:167], v3, s[40:43], s50 offen offset:3072 sc1
    v_and_b32 v38, 15, v1
    v_lshlrev_b32 v35, 12, v38
    v_lshlrev_b32 v38, 4, v38
    v_lshl_add_u32 v38, v2, 12, v38
    s_lshl_b32 s51, s44, 8
    v_add_u32 v38, s51, v38
    s_lshl_b32 s51, s44, 4
    v_add_u32 v35, s51, v35
    v_lshrrev_b32 v35, 3, v1
    v_lshlrev_b32 v35, 12, v35
    v_and_b32 v5, 7, v1
    v_lshl_add_u32 v35, v5, 4, v35
    v_bfe_u32 v5, v0, 7, 1
    v_lshlrev_b32 v5, 6, v5
    v_bfe_u32 v7, v0, 5, 2
    v_lshl_add_u32 v5, v7, 4, v5
    v_and_b32 v7, 1, v0
    v_lshl_add_u32 v5, v7, 3, v5
    v_add_u32 v5, 2048, v5
    s_cmp_ge_u32 s44, 4
    s_cselect_b64 vcc, -1, 0
    v_cndmask_b32 v39, v4, v5, vcc
    s_cmp_eq_u32 s60, 0
    s_cbranch_scc1 fused_kernel_cb4
    s_barrier
fused_kernel_cb4:
    ds_read_b128 v[76:79], v3 offset:32768
    ds_read_b128 v[80:83], v3 offset:33792
    ds_read_b128 v[84:87], v45 offset:0
    ds_read_b128 v[88:91], v45 offset:1024
    ds_read_b128 v[92:95], v3 offset:34816
    ds_read_b128 v[96:99], v3 offset:35840
    ds_read_b128 v[100:103], v45 offset:2048
    s_waitcnt lgkmcnt(6)
    s_waitcnt vmcnt(15)
    v_mfma_f32_16x16x32_bf16 v[56:59], v[104:107], v[76:79], 0
    ds_read_b128 v[76:79], v45 offset:3072
    s_waitcnt lgkmcnt(6)
    v_mfma_f32_16x16x32_bf16 v[60:63], v[104:107], v[80:83], 0
    ds_read_b128 v[80:83], v3 offset:36864
    s_waitcnt lgkmcnt(6)
    v_mfma_f32_16x16x32_bf16 v[64:67], v[104:107], v[84:87], 0
    ds_read_b128 v[84:87], v3 offset:37888
    s_waitcnt lgkmcnt(6)
    v_mfma_f32_16x16x32_bf16 v[68:71], v[104:107], v[88:91], 0
    ds_read_b128 v[88:91], v45 offset:4096
    s_waitcnt lgkmcnt(6)
    s_waitcnt vmcnt(14)
    v_mfma_f32_16x16x32_bf16 v[56:59], v[108:111], v[92:95], v[56:59]
    ds_read_b128 v[92:95], v45 offset:5120
    s_waitcnt lgkmcnt(6)
    v_mfma_f32_16x16x32_bf16 v[60:63], v[108:111], v[96:99], v[60:63]
    ds_read_b128 v[96:99], v3 offset:38912
    s_waitcnt lgkmcnt(6)
    v_mfma_f32_16x16x32_bf16 v[64:67], v[108:111], v[100:103], v[64:67]
    ds_read_b128 v[100:103], v3 offset:39936
    s_waitcnt lgkmcnt(6)
    v_mfma_f32_16x16x32_bf16 v[68:71], v[108:111], v[76:79], v[68:71]
    ds_read_b128 v[76:79], v45 offset:6144
    s_waitcnt lgkmcnt(6)
    s_waitcnt vmcnt(13)
    v_mfma_f32_16x16x32_bf16 v[56:59], v[112:115], v[80:83], v[56:59]
    ds_read_b128 v[80:83], v45 offset:7168
    s_waitcnt lgkmcnt(6)
    v_mfma_f32_16x16x32_bf16 v[60:63], v[112:115], v[84:87], v[60:63]
    ds_read_b128 v[84:87], v3 offset:40960
    s_waitcnt lgkmcnt(6)
    v_mfma_f32_16x16x32_bf16 v[64:67], v[112:115], v[88:91], v[64:67]
    ds_read_b128 v[88:91], v3 offset:41984
    s_waitcnt lgkmcnt(6)
    v_mfma_f32_16x16x32_bf16 v[68:71], v[112:115], v[92:95], v[68:71]
    ds_read_b128 v[92:95], v45 offset:8192
    s_waitcnt lgkmcnt(6)
    s_waitcnt vmcnt(12)
    v_mfma_f32_16x16x32_bf16 v[56:59], v[116:119], v[96:99], v[56:59]
    ds_read_b128 v[96:99], v45 offset:9216
    s_waitcnt lgkmcnt(6)
    v_mfma_f32_16x16x32_bf16 v[60:63], v[116:119], v[100:103], v[60:63]
    ds_read_b128 v[100:103], v3 offset:43008
    s_waitcnt lgkmcnt(6)
    v_mfma_f32_16x16x32_bf16 v[64:67], v[116:119], v[76:79], v[64:67]
    ds_read_b128 v[76:79], v3 offset:44032
    s_waitcnt lgkmcnt(6)
    v_mfma_f32_16x16x32_bf16 v[68:71], v[116:119], v[80:83], v[68:71]
    ds_read_b128 v[80:83], v45 offset:10240
    s_waitcnt lgkmcnt(6)
    s_waitcnt vmcnt(11)
    v_mfma_f32_16x16x32_bf16 v[56:59], v[120:123], v[84:87], v[56:59]
    ds_read_b128 v[84:87], v45 offset:11264
    s_waitcnt lgkmcnt(6)
    v_mfma_f32_16x16x32_bf16 v[60:63], v[120:123], v[88:91], v[60:63]
    ds_read_b128 v[88:91], v3 offset:45056
    s_waitcnt lgkmcnt(6)
    v_mfma_f32_16x16x32_bf16 v[64:67], v[120:123], v[92:95], v[64:67]
    ds_read_b128 v[92:95], v3 offset:46080
    s_waitcnt lgkmcnt(6)
    v_mfma_f32_16x16x32_bf16 v[68:71], v[120:123], v[96:99], v[68:71]
    ds_read_b128 v[96:99], v45 offset:12288
    s_waitcnt lgkmcnt(6)
    s_waitcnt vmcnt(10)
    v_mfma_f32_16x16x32_bf16 v[56:59], v[124:127], v[100:103], v[56:59]
    ds_read_b128 v[100:103], v45 offset:13312
    s_waitcnt lgkmcnt(6)
    v_mfma_f32_16x16x32_bf16 v[60:63], v[124:127], v[76:79], v[60:63]
    ds_read_b128 v[76:79], v3 offset:47104
    s_waitcnt lgkmcnt(6)
    v_mfma_f32_16x16x32_bf16 v[64:67], v[124:127], v[80:83], v[64:67]
    ds_read_b128 v[80:83], v3 offset:48128
    s_waitcnt lgkmcnt(6)
    v_mfma_f32_16x16x32_bf16 v[68:71], v[124:127], v[84:87], v[68:71]
    ds_read_b128 v[84:87], v45 offset:14336
    s_waitcnt lgkmcnt(6)
    s_waitcnt vmcnt(9)
    v_mfma_f32_16x16x32_bf16 v[56:59], v[128:131], v[88:91], v[56:59]
    ds_read_b128 v[88:91], v45 offset:15360
    s_waitcnt lgkmcnt(6)
    v_mfma_f32_16x16x32_bf16 v[60:63], v[128:131], v[92:95], v[60:63]
    ds_read_b128 v[92:95], v3 offset:49152
    s_waitcnt lgkmcnt(6)
    v_mfma_f32_16x16x32_bf16 v[64:67], v[128:131], v[96:99], v[64:67]
    ds_read_b128 v[96:99], v3 offset:50176
    s_waitcnt lgkmcnt(6)
    v_mfma_f32_16x16x32_bf16 v[68:71], v[128:131], v[100:103], v[68:71]
    ds_read_b128 v[100:103], v45 offset:16384
    s_waitcnt lgkmcnt(6)
    s_waitcnt vmcnt(8)
    v_mfma_f32_16x16x32_bf16 v[56:59], v[132:135], v[76:79], v[56:59]
    ds_read_b128 v[76:79], v45 offset:17408
    s_waitcnt lgkmcnt(6)
    v_mfma_f32_16x16x32_bf16 v[60:63], v[132:135], v[80:83], v[60:63]
    ds_read_b128 v[80:83], v3 offset:51200
    s_waitcnt lgkmcnt(6)
    v_mfma_f32_16x16x32_bf16 v[64:67], v[132:135], v[84:87], v[64:67]
    ds_read_b128 v[84:87], v3 offset:52224
    s_waitcnt lgkmcnt(6)
    v_mfma_f32_16x16x32_bf16 v[68:71], v[132:135], v[88:91], v[68:71]
    ds_read_b128 v[88:91], v45 offset:18432
    s_waitcnt lgkmcnt(6)
    s_waitcnt vmcnt(7)
    v_mfma_f32_16x16x32_bf16 v[56:59], v[136:139], v[92:95], v[56:59]
    ds_read_b128 v[92:95], v45 offset:19456
    s_waitcnt lgkmcnt(6)
    v_mfma_f32_16x16x32_bf16 v[60:63], v[136:139], v[96:99], v[60:63]
    ds_read_b128 v[96:99], v3 offset:53248
    s_waitcnt lgkmcnt(6)
    v_mfma_f32_16x16x32_bf16 v[64:67], v[136:139], v[100:103], v[64:67]
    ds_read_b128 v[100:103], v3 offset:54272
    s_waitcnt lgkmcnt(6)
    v_mfma_f32_16x16x32_bf16 v[68:71], v[136:139], v[76:79], v[68:71]
    ds_read_b128 v[76:79], v45 offset:20480
    s_waitcnt lgkmcnt(6)
    s_waitcnt vmcnt(6)
    v_mfma_f32_16x16x32_bf16 v[56:59], v[140:143], v[80:83], v[56:59]
    ds_read_b128 v[80:83], v45 offset:21504
    s_waitcnt lgkmcnt(6)
    v_mfma_f32_16x16x32_bf16 v[60:63], v[140:143], v[84:87], v[60:63]
    ds_read_b128 v[84:87], v3 offset:55296
    s_waitcnt lgkmcnt(6)
    v_mfma_f32_16x16x32_bf16 v[64:67], v[140:143], v[88:91], v[64:67]
    ds_read_b128 v[88:91], v3 offset:56320
    s_waitcnt lgkmcnt(6)
    v_mfma_f32_16x16x32_bf16 v[68:71], v[140:143], v[92:95], v[68:71]
    ds_read_b128 v[92:95], v45 offset:22528
    s_waitcnt lgkmcnt(6)
    s_waitcnt vmcnt(5)
    v_mfma_f32_16x16x32_bf16 v[56:59], v[144:147], v[96:99], v[56:59]
    ds_read_b128 v[96:99], v45 offset:23552
    s_waitcnt lgkmcnt(6)
    v_mfma_f32_16x16x32_bf16 v[60:63], v[144:147], v[100:103], v[60:63]
    ds_read_b128 v[100:103], v3 offset:57344
    s_waitcnt lgkmcnt(6)
    v_mfma_f32_16x16x32_bf16 v[64:67], v[144:147], v[76:79], v[64:67]
    ds_read_b128 v[76:79], v3 offset:58368
    s_waitcnt lgkmcnt(6)
    v_mfma_f32_16x16x32_bf16 v[68:71], v[144:147], v[80:83], v[68:71]
    ds_read_b128 v[80:83], v45 offset:24576
    s_waitcnt lgkmcnt(6)
    s_waitcnt vmcnt(4)
    v_mfma_f32_16x16x32_bf16 v[56:59], v[148:151], v[84:87], v[56:59]
    ds_read_b128 v[84:87], v45 offset:25600
    s_waitcnt lgkmcnt(6)
    v_mfma_f32_16x16x32_bf16 v[60:63], v[148:151], v[88:91], v[60:63]
    ds_read_b128 v[88:91], v3 offset:59392
    s_waitcnt lgkmcnt(6)
    v_mfma_f32_16x16x32_bf16 v[64:67], v[148:151], v[92:95], v[64:67]
    ds_read_b128 v[92:95], v3 offset:60416
    s_waitcnt lgkmcnt(6)
    v_mfma_f32_16x16x32_bf16 v[68:71], v[148:151], v[96:99], v[68:71]
    ds_read_b128 v[96:99], v45 offset:26624
    s_waitcnt lgkmcnt(6)
    s_waitcnt vmcnt(3)
    v_mfma_f32_16x16x32_bf16 v[56:59], v[152:155], v[100:103], v[56:59]
    ds_read_b128 v[100:103], v45 offset:27648
    s_waitcnt lgkmcnt(6)
    v_mfma_f32_16x16x32_bf16 v[60:63], v[152:155], v[76:79], v[60:63]
    ds_read_b128 v[76:79], v3 offset:61440
    s_waitcnt lgkmcnt(6)
    v_mfma_f32_16x16x32_bf16 v[64:67], v[152:155], v[80:83], v[64:67]
    ds_read_b128 v[80:83], v3 offset:62464
    s_waitcnt lgkmcnt(6)
    v_mfma_f32_16x16x32_bf16 v[68:71], v[152:155], v[84:87], v[68:71]
    ds_read_b128 v[84:87], v45 offset:28672
    s_waitcnt lgkmcnt(6)
    s_waitcnt vmcnt(2)
    v_mfma_f32_16x16x32_bf16 v[56:59], v[156:159], v[88:91], v[56:59]
    ds_read_b128 v[88:91], v45 offset:29696
    s_waitcnt lgkmcnt(6)
    v_mfma_f32_16x16x32_bf16 v[60:63], v[156:159], v[92:95], v[60:63]
    ds_read_b128 v[92:95], v3 offset:63488
    s_waitcnt lgkmcnt(6)
    v_mfma_f32_16x16x32_bf16 v[64:67], v[156:159], v[96:99], v[64:67]
    ds_read_b128 v[96:99], v3 offset:64512
    s_waitcnt lgkmcnt(6)
    v_mfma_f32_16x16x32_bf16 v[68:71], v[156:159], v[100:103], v[68:71]
    ds_read_b128 v[100:103], v45 offset:30720
    s_waitcnt lgkmcnt(6)
    s_waitcnt vmcnt(1)
    v_mfma_f32_16x16x32_bf16 v[56:59], v[160:163], v[76:79], v[56:59]
    ds_read_b128 v[76:79], v45 offset:31744
    s_waitcnt lgkmcnt(6)
    v_mfma_f32_16x16x32_bf16 v[60:63], v[160:163], v[80:83], v[60:63]
    s_waitcnt lgkmcnt(5)
    v_mfma_f32_16x16x32_bf16 v[64:67], v[160:163], v[84:87], v[64:67]
    s_waitcnt lgkmcnt(4)
    v_mfma_f32_16x16x32_bf16 v[68:71], v[160:163], v[88:91], v[68:71]
    s_waitcnt lgkmcnt(3)
    s_waitcnt vmcnt(0)
    v_mfma_f32_16x16x32_bf16 v[56:59], v[164:167], v[92:95], v[56:59]
    s_waitcnt lgkmcnt(2)
    v_mfma_f32_16x16x32_bf16 v[60:63], v[164:167], v[96:99], v[60:63]
    s_waitcnt lgkmcnt(1)
    v_mfma_f32_16x16x32_bf16 v[64:67], v[164:167], v[100:103], v[64:67]
    s_waitcnt lgkmcnt(0)
    v_mfma_f32_16x16x32_bf16 v[68:71], v[164:167], v[76:79], v[68:71]
    s_cmp_eq_u32 s60, 1
    s_cbranch_scc1 fused_kernel_cb5
    s_barrier
fused_kernel_cb5:
    v_cvt_pk_bf16_f32 v76, 0, v56
    v_cvt_pk_bf16_f32 v77, 0, v57
    v_cvt_pk_bf16_f32 v78, 0, v58
    v_cvt_pk_bf16_f32 v79, 0, v59
    v_mul_f32 v80, 0x3fb8aa3b, v76
    v_mul_f32 v81, 0x3fb8aa3b, v77
    v_mul_f32 v82, 0x3fb8aa3b, v78
    v_mul_f32 v83, 0x3fb8aa3b, v79
    v_exp_f32 v80, v80
    v_exp_f32 v81, v81
    v_exp_f32 v82, v82
    v_exp_f32 v83, v83
    v_cmp_lt_f32 s[64:65], 0, v76
    v_cmp_lt_f32 s[66:67], 0, v77
    v_cmp_lt_f32 s[68:69], 0, v78
    v_cmp_lt_f32 s[70:71], 0, v79
    v_add_f32 v76, 1.0, v76
    v_add_f32 v77, 1.0, v77
    v_add_f32 v78, 1.0, v78
    v_add_f32 v79, 1.0, v79
    v_cndmask_b32 v76, v80, v76, s[64:65]
    v_cndmask_b32 v77, v81, v77, s[66:67]
    v_cndmask_b32 v78, v82, v78, s[68:69]
    v_cndmask_b32 v79, v83, v79, s[70:71]
    v_cvt_pk_bf16_f32 v76, 0, v76
    v_cvt_pk_bf16_f32 v77, 0, v77
    v_cvt_pk_bf16_f32 v78, 0, v78
    v_cvt_pk_bf16_f32 v79, 0, v79
    v_add_f32 v76, 0x358637bd, v76
    v_add_f32 v77, 0x358637bd, v77
    v_add_f32 v78, 0x358637bd, v78
    v_add_f32 v79, 0x358637bd, v79
    v_cvt_pk_bf16_f32 v88, v76, v77
    v_cvt_pk_bf16_f32 v89, v78, v79
    v_cvt_pk_bf16_f32 v92, v64, v65
    v_cvt_pk_bf16_f32 v93, v66, v67
    v_cvt_pk_bf16_f32 v76, 0, v60
    v_cvt_pk_bf16_f32 v77, 0, v61
    v_cvt_pk_bf16_f32 v78, 0, v62
    v_cvt_pk_bf16_f32 v79, 0, v63
    v_mul_f32 v80, 0x3fb8aa3b, v76
    v_mul_f32 v81, 0x3fb8aa3b, v77
    v_mul_f32 v82, 0x3fb8aa3b, v78
    v_mul_f32 v83, 0x3fb8aa3b, v79
    v_exp_f32 v80, v80
    v_exp_f32 v81, v81
    v_exp_f32 v82, v82
    v_exp_f32 v83, v83
    v_cmp_lt_f32 s[64:65], 0, v76
    v_cmp_lt_f32 s[66:67], 0, v77
    v_cmp_lt_f32 s[68:69], 0, v78
    v_cmp_lt_f32 s[70:71], 0, v79
    v_add_f32 v76, 1.0, v76
    v_add_f32 v77, 1.0, v77
    v_add_f32 v78, 1.0, v78
    v_add_f32 v79, 1.0, v79
    v_cndmask_b32 v76, v80, v76, s[64:65]
    v_cndmask_b32 v77, v81, v77, s[66:67]
    v_cndmask_b32 v78, v82, v78, s[68:69]
    v_cndmask_b32 v79, v83, v79, s[70:71]
    v_cvt_pk_bf16_f32 v76, 0, v76
    v_cvt_pk_bf16_f32 v77, 0, v77
    v_cvt_pk_bf16_f32 v78, 0, v78
    v_cvt_pk_bf16_f32 v79, 0, v79
    v_add_f32 v76, 0x358637bd, v76
    v_add_f32 v77, 0x358637bd, v77
    v_add_f32 v78, 0x358637bd, v78
    v_add_f32 v79, 0x358637bd, v79
    v_cvt_pk_bf16_f32 v90, v76, v77
    v_cvt_pk_bf16_f32 v91, v78, v79
    v_cvt_pk_bf16_f32 v94, v68, v69
    v_cvt_pk_bf16_f32 v95, v70, v71
    v_mfma_f32_16x16x16_bf16 v[48:51], v[88:89], v[92:93], 0
    v_mfma_f32_16x16x16_bf16 v[96:99], v[88:89], v[10:11], 0
    v_mfma_f32_16x16x16_bf16 v[52:55], v[90:91], v[94:95], 0
    v_mfma_f32_16x16x16_bf16 v[100:103], v[90:91], v[10:11], 0
    s_lshl_b32 s50, s44, 12
    v_add_u32 v6, s50, v45
    v_add_u32 v7, 0x10000, v4
    s_nop 1
    ds_write_b128 v6, v[48:51] offset:32768
    s_nop 0
    ds_write_b128 v6, v[52:55] offset:33792
    ds_write_b128 v6, v[96:99] offset:34816
    ds_write_b128 v6, v[100:103] offset:35840
    s_waitcnt lgkmcnt(0)
    s_barrier
    ds_read_b64 v[56:57], v7 offset:32768
    ds_read_b64 v[58:59], v7 offset:36864
    ds_read_b64 v[60:61], v7 offset:40960
    ds_read_b64 v[62:63], v7 offset:45056
    ds_read_b64 v[64:65], v7 offset:49152
    ds_read_b64 v[66:67], v7 offset:53248
    ds_read_b64 v[68:69], v7 offset:57344
    ds_read_b64 v[70:71], v7 offset:61440
    s_waitcnt lgkmcnt(0)
    v_pk_add_f32 v[56:57], v[56:57], v[58:59]
    v_pk_add_f32 v[56:57], v[56:57], v[60:61]
    v_pk_add_f32 v[56:57], v[56:57], v[62:63]
    v_pk_add_f32 v[56:57], v[56:57], v[64:65]
    v_pk_add_f32 v[56:57], v[56:57], v[66:67]
    v_pk_add_f32 v[56:57], v[56:57], v[68:69]
    v_pk_add_f32 v[56:57], v[56:57], v[70:71]
    s_lshl_b32 s50, s56, 4
    s_lshl_b32 s51, s45, 1
    s_add_u32 s50, s50, s51
    s_add_u32 s50, s50, s55
    s_lshl_b32 s50, s50, 12
    s_add_u32 s50, s50, 0x1000000
    s_cmp_ge_u32 s44, 4
    s_cselect_b32 s51, 3, -1
    s_mov_b32 exec_lo, s51
    s_mov_b32 exec_hi, s51
    buffer_store_dwordx2 v[56:57], v39, s[40:43], s50 offen sc1
    s_mov_b64 exec, -1
    s_barrier
    ds_read_b64_tr_b16 v[76:77], v32 offset:0
    ds_read_b64_tr_b16 v[78:79], v32 offset:256
    ds_read_b64_tr_b16 v[80:81], v33 offset:0
    ds_read_b64_tr_b16 v[82:83], v33 offset:256
    ds_read_b64_tr_b16 v[84:85], v32 offset:2048
    ds_read_b64_tr_b16 v[86:87], v32 offset:2304
    ds_read_b64_tr_b16 v[88:89], v33 offset:2048
    ds_read_b64_tr_b16 v[90:91], v33 offset:2304
    ds_read_b64_tr_b16 v[92:93], v32 offset:4096
    ds_read_b64_tr_b16 v[94:95], v32 offset:4352
    ds_read_b64_tr_b16 v[96:97], v33 offset:4096
    ds_read_b64_tr_b16 v[98:99], v33 offset:4352
    ds_read_b64_tr_b16 v[100:101], v32 offset:6144
    ds_read_b64_tr_b16 v[102:103], v32 offset:6400
    s_waitcnt lgkmcnt(12)
    v_mfma_f32_16x16x32_bf16 v[48:51], v[76:79], v[104:107], 0
    ds_read_b64_tr_b16 v[76:77], v33 offset:6144
    ds_read_b64_tr_b16 v[78:79], v33 offset:6400
    s_waitcnt lgkmcnt(12)
    v_mfma_f32_16x16x32_bf16 v[52:55], v[80:83], v[104:107], 0
    ds_read_b64_tr_b16 v[80:81], v32 offset:8192
    ds_read_b64_tr_b16 v[82:83], v32 offset:8448
    s_waitcnt lgkmcnt(12)
    v_mfma_f32_16x16x32_bf16 v[48:51], v[84:87], v[108:111], v[48:51]
    ds_read_b64_tr_b16 v[84:85], v33 offset:8192
    ds_read_b64_tr_b16 v[86:87], v33 offset:8448
    s_waitcnt lgkmcnt(12)
    v_mfma_f32_16x16x32_bf16 v[52:55], v[88:91], v[108:111], v[52:55]
    ds_read_b64_tr_b16 v[88:89], v32 offset:10240
    ds_read_b64_tr_b16 v[90:91], v32 offset:10496
    s_waitcnt lgkmcnt(12)
    v_mfma_f32_16x16x32_bf16 v[48:51], v[92:95], v[112:115], v[48:51]
    ds_read_b64_tr_b16 v[92:93], v33 offset:10240
    ds_read_b64_tr_b16 v[94:95], v33 offset:10496
    s_waitcnt lgkmcnt(12)
    v_mfma_f32_16x16x32_bf16 v[52:55], v[96:99], v[112:115], v[52:55]
    ds_read_b64_tr_b16 v[96:97], v32 offset:12288
    ds_read_b64_tr_b16 v[98:99], v32 offset:12544
    s_waitcnt lgkmcnt(12)
    v_mfma_f32_16x16x32_bf16 v[48:51], v[100:103], v[116:119], v[48:51]
    ds_read_b64_tr_b16 v[100:101], v33 offset:12288
    ds_read_b64_tr_b16 v[102:103], v33 offset:12544
    s_waitcnt lgkmcnt(12)
    v_mfma_f32_16x16x32_bf16 v[52:55], v[76:79], v[116:119], v[52:55]
    ds_read_b64_tr_b16 v[76:77], v32 offset:14336
    ds_read_b64_tr_b16 v[78:79], v32 offset:14592
    s_waitcnt lgkmcnt(12)
    v_mfma_f32_16x16x32_bf16 v[48:51], v[80:83], v[120:123], v[48:51]
    ds_read_b64_tr_b16 v[80:81], v33 offset:14336
    ds_read_b64_tr_b16 v[82:83], v33 offset:14592
    s_waitcnt lgkmcnt(12)
    v_mfma_f32_16x16x32_bf16 v[52:55], v[84:87], v[120:123], v[52:55]
    ds_read_b64_tr_b16 v[84:85], v32 offset:16384
    ds_read_b64_tr_b16 v[86:87], v32 offset:16640
    s_waitcnt lgkmcnt(12)
    v_mfma_f32_16x16x32_bf16 v[48:51], v[88:91], v[124:127], v[48:51]
    ds_read_b64_tr_b16 v[88:89], v33 offset:16384
    ds_read_b64_tr_b16 v[90:91], v33 offset:16640
    s_waitcnt lgkmcnt(12)
    v_mfma_f32_16x16x32_bf16 v[52:55], v[92:95], v[124:127], v[52:55]
    ds_read_b64_tr_b16 v[92:93], v32 offset:18432
    ds_read_b64_tr_b16 v[94:95], v32 offset:18688
    s_waitcnt lgkmcnt(12)
    v_mfma_f32_16x16x32_bf16 v[48:51], v[96:99], v[128:131], v[48:51]
    ds_read_b64_tr_b16 v[96:97], v33 offset:18432
    ds_read_b64_tr_b16 v[98:99], v33 offset:18688
    s_waitcnt lgkmcnt(12)
    v_mfma_f32_16x16x32_bf16 v[52:55], v[100:103], v[128:131], v[52:55]
    ds_read_b64_tr_b16 v[100:101], v32 offset:20480
    ds_read_b64_tr_b16 v[102:103], v32 offset:20736
    s_waitcnt lgkmcnt(12)
    v_mfma_f32_16x16x32_bf16 v[48:51], v[76:79], v[132:135], v[48:51]
    ds_read_b64_tr_b16 v[76:77], v33 offset:20480
    ds_read_b64_tr_b16 v[78:79], v33 offset:20736
    s_waitcnt lgkmcnt(12)
    v_mfma_f32_16x16x32_bf16 v[52:55], v[80:83], v[132:135], v[52:55]
    ds_read_b64_tr_b16 v[80:81], v32 offset:22528
    ds_read_b64_tr_b16 v[82:83], v32 offset:22784
    s_waitcnt lgkmcnt(12)
    v_mfma_f32_16x16x32_bf16 v[48:51], v[84:87], v[136:139], v[48:51]
    ds_read_b64_tr_b16 v[84:85], v33 offset:22528
    ds_read_b64_tr_b16 v[86:87], v33 offset:22784
    s_waitcnt lgkmcnt(12)
    v_mfma_f32_16x16x32_bf16 v[52:55], v[88:91], v[136:139], v[52:55]
    ds_read_b64_tr_b16 v[88:89], v32 offset:24576
    ds_read_b64_tr_b16 v[90:91], v32 offset:24832
    s_waitcnt lgkmcnt(12)
    v_mfma_f32_16x16x32_bf16 v[48:51], v[92:95], v[140:143], v[48:51]
    ds_read_b64_tr_b16 v[92:93], v33 offset:24576
    ds_read_b64_tr_b16 v[94:95], v33 offset:24832
    s_waitcnt lgkmcnt(12)
    v_mfma_f32_16x16x32_bf16 v[52:55], v[96:99], v[140:143], v[52:55]
    ds_read_b64_tr_b16 v[96:97], v32 offset:26624
    ds_read_b64_tr_b16 v[98:99], v32 offset:26880
    s_waitcnt lgkmcnt(12)
    v_mfma_f32_16x16x32_bf16 v[48:51], v[100:103], v[144:147], v[48:51]
    ds_read_b64_tr_b16 v[100:101], v33 offset:26624
    ds_read_b64_tr_b16 v[102:103], v33 offset:26880
    s_waitcnt lgkmcnt(12)
    v_mfma_f32_16x16x32_bf16 v[52:55], v[76:79], v[144:147], v[52:55]
    ds_read_b64_tr_b16 v[76:77], v32 offset:28672
    ds_read_b64_tr_b16 v[78:79], v32 offset:28928
    s_waitcnt lgkmcnt(12)
    v_mfma_f32_16x16x32_bf16 v[48:51], v[80:83], v[148:151], v[48:51]
    ds_read_b64_tr_b16 v[80:81], v33 offset:28672
    ds_read_b64_tr_b16 v[82:83], v33 offset:28928
    s_waitcnt lgkmcnt(12)
    v_mfma_f32_16x16x32_bf16 v[52:55], v[84:87], v[148:151], v[52:55]
    ds_read_b64_tr_b16 v[84:85], v32 offset:30720
    ds_read_b64_tr_b16 v[86:87], v32 offset:30976
    s_waitcnt lgkmcnt(12)
    v_mfma_f32_16x16x32_bf16 v[48:51], v[88:91], v[152:155], v[48:51]
    ds_read_b64_tr_b16 v[88:89], v33 offset:30720
    ds_read_b64_tr_b16 v[90:91], v33 offset:30976
    s_waitcnt lgkmcnt(12)
    v_mfma_f32_16x16x32_bf16 v[52:55], v[92:95], v[152:155], v[52:55]
    s_waitcnt lgkmcnt(10)
    v_mfma_f32_16x16x32_bf16 v[48:51], v[96:99], v[156:159], v[48:51]
    s_waitcnt lgkmcnt(8)
    v_mfma_f32_16x16x32_bf16 v[52:55], v[100:103], v[156:159], v[52:55]
    s_waitcnt lgkmcnt(6)
    v_mfma_f32_16x16x32_bf16 v[48:51], v[76:79], v[160:163], v[48:51]
    s_waitcnt lgkmcnt(4)
    v_mfma_f32_16x16x32_bf16 v[52:55], v[80:83], v[160:163], v[52:55]
    s_waitcnt lgkmcnt(2)
    v_mfma_f32_16x16x32_bf16 v[48:51], v[84:87], v[164:167], v[48:51]
    s_waitcnt lgkmcnt(0)
    v_mfma_f32_16x16x32_bf16 v[52:55], v[88:91], v[164:167], v[52:55]
    s_nop 5
    v_cvt_pk_bf16_f32 v76, 0, v48
    v_cvt_pk_bf16_f32 v77, 0, v49
    v_cvt_pk_bf16_f32 v78, 0, v50
    v_cvt_pk_bf16_f32 v79, 0, v51
    v_mul_f32 v80, 0x3fb8aa3b, v76
    v_mul_f32 v81, 0x3fb8aa3b, v77
    v_mul_f32 v82, 0x3fb8aa3b, v78
    v_mul_f32 v83, 0x3fb8aa3b, v79
    v_exp_f32 v80, v80
    v_exp_f32 v81, v81
    v_exp_f32 v82, v82
    v_exp_f32 v83, v83
    v_cmp_lt_f32 s[64:65], 0, v76
    v_cmp_lt_f32 s[66:67], 0, v77
    v_cmp_lt_f32 s[68:69], 0, v78
    v_cmp_lt_f32 s[70:71], 0, v79
    v_add_f32 v76, 1.0, v76
    v_add_f32 v77, 1.0, v77
    v_add_f32 v78, 1.0, v78
    v_add_f32 v79, 1.0, v79
    v_cndmask_b32 v76, v80, v76, s[64:65]
    v_cndmask_b32 v77, v81, v77, s[66:67]
    v_cndmask_b32 v78, v82, v78, s[68:69]
    v_cndmask_b32 v79, v83, v79, s[70:71]
    v_cvt_pk_bf16_f32 v76, 0, v76
    v_cvt_pk_bf16_f32 v77, 0, v77
    v_cvt_pk_bf16_f32 v78, 0, v78
    v_cvt_pk_bf16_f32 v79, 0, v79
    v_add_f32 v76, 0x358637bd, v76
    v_add_f32 v77, 0x358637bd, v77
    v_add_f32 v78, 0x358637bd, v78
    v_add_f32 v79, 0x358637bd, v79
    v_cvt_pk_bf16_f32 v12, v76, v77
    v_cvt_pk_bf16_f32 v13, v78, v79
    v_cvt_pk_bf16_f32 v76, 0, v52
    v_cvt_pk_bf16_f32 v77, 0, v53
    v_cvt_pk_bf16_f32 v78, 0, v54
    v_cvt_pk_bf16_f32 v79, 0, v55
    v_mul_f32 v80, 0x3fb8aa3b, v76
    v_mul_f32 v81, 0x3fb8aa3b, v77
    v_mul_f32 v82, 0x3fb8aa3b, v78
    v_mul_f32 v83, 0x3fb8aa3b, v79
    v_exp_f32 v80, v80
    v_exp_f32 v81, v81
    v_exp_f32 v82, v82
    v_exp_f32 v83, v83
    v_cmp_lt_f32 s[64:65], 0, v76
    v_cmp_lt_f32 s[66:67], 0, v77
    v_cmp_lt_f32 s[68:69], 0, v78
    v_cmp_lt_f32 s[70:71], 0, v79
    v_add_f32 v76, 1.0, v76
    v_add_f32 v77, 1.0, v77
    v_add_f32 v78, 1.0, v78
    v_add_f32 v79, 1.0, v79
    v_cndmask_b32 v76, v80, v76, s[64:65]
    v_cndmask_b32 v77, v81, v77, s[66:67]
    v_cndmask_b32 v78, v82, v78, s[68:69]
    v_cndmask_b32 v79, v83, v79, s[70:71]
    v_cvt_pk_bf16_f32 v76, 0, v76
    v_cvt_pk_bf16_f32 v77, 0, v77
    v_cvt_pk_bf16_f32 v78, 0, v78
    v_cvt_pk_bf16_f32 v79, 0, v79
    v_add_f32 v76, 0x358637bd, v76
    v_add_f32 v77, 0x358637bd, v77
    v_add_f32 v78, 0x358637bd, v78
    v_add_f32 v79, 0x358637bd, v79
    v_cvt_pk_bf16_f32 v14, v76, v77
    v_cvt_pk_bf16_f32 v15, v78, v79
    v_bfe_u32 v5, v1, 2, 2
    v_lshl_add_u32 v6, v2, 2, v5
    v_bfe_u32 v7, v6, 1, 2
    v_lshlrev_b32 v5, 7, v6
    v_and_b32 v6, 3, v1
    v_lshl_add_u32 v5, v6, 3, v5
    v_xor_b32 v6, 0, v7
    v_lshl_add_u32 v24, v6, 5, v5
    v_xor_b32 v6, 1, v7
    v_lshl_add_u32 v25, v6, 5, v5
    v_xor_b32 v6, 2, v7
    v_lshl_add_u32 v26, v6, 5, v5
    v_xor_b32 v6, 3, v7
    v_lshl_add_u32 v27, v6, 5, v5
    s_lshl_b32 s51, s60, 12
    s_lshl_b32 s51, s60, 12
    s_add_u32 s51, s51, 0x10000
    v_add_u32 v31, s51, v24
    v_add_u32 v40, 0x10000, v31
    v_add_u32 v32, s51, v25
    v_add_u32 v41, 0x10000, v32
    v_add_u32 v33, s51, v26
    v_add_u32 v42, 0x10000, v33
    v_add_u32 v34, s51, v27
    v_add_u32 v43, 0x10000, v34
    s_mul_i32 s51, s56, 224
    s_bfe_u32 s50, s51, 0x10005
    s_lshl_b32 s50, s50, 1
    v_bfe_u32 v5, v1, 2, 2
    v_lshl_add_u32 v5, v2, 2, v5
    v_and_b32 v6, 7, v5
    v_lshlrev_b32 v6, 1, v6
    v_lshlrev_b32 v5, 8, v5
    v_and_b32 v7, 1, v1
    v_lshl_add_u32 v5, v7, 3, v5
    v_bfe_u32 v7, v1, 1, 1
    v_add_u32 v7, s50, v7
    v_add_u32 v8, 0, v7
    v_xor_b32 v8, v8, v6
    v_lshl_add_u32 v24, v8, 4, v5
    v_add_u32 v8, 2, v7
    v_xor_b32 v8, v8, v6
    v_lshl_add_u32 v25, v8, 4, v5
    v_add_u32 v8, 4, v7
    v_xor_b32 v8, v8, v6
    v_lshl_add_u32 v26, v8, 4, v5
    v_add_u32 v8, 6, v7
    v_xor_b32 v8, v8, v6
    v_lshl_add_u32 v27, v8, 4, v5
    v_add_u32 v8, 8, v7
    v_xor_b32 v8, v8, v6
    v_lshl_add_u32 v28, v8, 4, v5
    v_add_u32 v8, 10, v7
    v_xor_b32 v8, v8, v6
    v_lshl_add_u32 v29, v8, 4, v5
    v_add_u32 v8, 12, v7
    v_xor_b32 v8, v8, v6
    v_lshl_add_u32 v30, v8, 4, v5
    s_cmp_eq_u32 s47, 0
    s_cbranch_scc1 fused_kernel_fm6
    s_waitcnt vmcnt(0)
fused_kernel_fm6:
    s_barrier
    s_barrier
    s_mov_b32 s53, 0
    v_mov_b32 v120, 0
    v_mov_b32 v121, 0
    v_mov_b32 v122, 0
    v_mov_b32 v123, 0
    v_mov_b32 v124, 0
    v_mov_b32 v125, 0
    v_mov_b32 v126, 0
    v_mov_b32 v127, 0
fused_kernel_pp7:
    s_lshl_b32 s50, s56, 16
    s_add_u32 s50, s50, 0x1000000
    s_add_u32 s65, s50, 0x4000
    s_add_u32 s66, s50, 0x8000
    s_add_u32 s67, s50, 0xc000
    buffer_load_dwordx4 v[104:107], v38, s[40:43], s50 offen sc1
    buffer_load_dwordx4 v[108:111], v38, s[40:43], s65 offen sc1
    buffer_load_dwordx4 v[112:115], v38, s[40:43], s66 offen sc1
    buffer_load_dwordx4 v[116:119], v38, s[40:43], s67 offen sc1
    s_cmp_lg_u32 s44, 0
    s_cbranch_scc1 fused_kernel_pz9
    buffer_load_dwordx4 v[120:123], v35, s[40:43], s50 offen offset:2048 sc1
    buffer_load_dwordx4 v[124:127], v35, s[40:43], s66 offen offset:2048 sc1
fused_kernel_pz9:
    v_mov_b32 v6, 61440
    ds_read_b32 v8, v6
    s_waitcnt lgkmcnt(0)
    v_readfirstlane_b32 s51, v8
    s_nop 0
    s_cmp_lg_u32 s51, 0
    s_cbranch_scc1 fused_kernel_cfallback
    s_waitcnt vmcnt(0)
    v_max3_u32 v5, v104, v105, v106
    v_max3_u32 v6, v107, v108, v109
    v_max3_u32 v5, v5, v110, v111
    v_max3_u32 v6, v6, v112, v113
    v_max3_u32 v5, v5, v114, v115
    v_max3_u32 v6, v6, v116, v117
    v_max3_u32 v5, v5, v118, v119
    v_max3_u32 v6, v6, v120, v121
    v_max3_u32 v5, v5, v122, v123
    v_max3_u32 v6, v6, v124, v125
    v_max3_u32 v5, v5, v126, v127
    v_max_u32 v5, v5, v6
    v_cmp_eq_u32 vcc, -1, v5
    s_add_u32 s53, s53, 1
    s_nop 4
    s_cbranch_vccz fused_kernel_px8
    s_cmp_lt_u32 s53, 4096
    s_cbranch_scc1 fused_kernel_pp7
fused_kernel_px8:
    v_pk_add_f32 v[104:105], v[104:105], v[108:109]
    v_pk_add_f32 v[112:113], v[112:113], v[116:117]
    v_pk_add_f32 v[106:107], v[106:107], v[110:111]
    v_pk_add_f32 v[114:115], v[114:115], v[118:119]
    v_pk_add_f32 v[104:105], v[104:105], v[112:113]
    v_pk_add_f32 v[106:107], v[106:107], v[114:115]
    v_mov_b32 v108, v104
    v_mov_b32 v109, v105
    v_mov_b32 v110, v106
    v_mov_b32 v111, v107
    v_permlane16_swap_b32 v104, v108
    v_permlane16_swap_b32 v105, v109
    v_permlane16_swap_b32 v106, v110
    v_permlane16_swap_b32 v107, v111
    v_pk_add_f32 v[104:105], v[104:105], v[108:109]
    v_pk_add_f32 v[106:107], v[106:107], v[110:111]
    v_mov_b32 v108, v104
    v_mov_b32 v109, v105
    v_mov_b32 v110, v106
    v_mov_b32 v111, v107
    v_permlane32_swap_b32 v104, v108
    v_permlane32_swap_b32 v105, v109
    v_permlane32_swap_b32 v106, v110
    v_permlane32_swap_b32 v107, v111
    v_pk_add_f32 v[104:105], v[104:105], v[108:109]
    v_pk_add_f32 v[106:107], v[106:107], v[110:111]
    v_cvt_pk_bf16_f32 v104, v104, v105
    v_cvt_pk_bf16_f32 v105, v106, v107
    s_lshl_b32 s51, s44, 7
    v_lshl_add_u32 v5, v1, 3, s51
    s_mov_b64 exec, 0xffff
    ds_write_b64 v5, v[104:105] offset:57344
    s_mov_b64 exec, -1
    s_cmp_lg_u32 s44, 0
    s_cbranch_scc1 fused_kernel_pz10
    v_pk_add_f32 v[120:121], v[120:121], v[124:125]
    v_pk_add_f32 v[122:123], v[122:123], v[126:127]
    s_nop 0
    v_add_f32_dpp v120, v120, v120 row_ror:8 row_mask:0xf bank_mask:0xf
    v_add_f32_dpp v121, v121, v121 row_ror:8 row_mask:0xf bank_mask:0xf
    v_add_f32_dpp v122, v122, v122 row_ror:8 row_mask:0xf bank_mask:0xf
    v_add_f32_dpp v123, v123, v123 row_ror:8 row_mask:0xf bank_mask:0xf
    v_mov_b32 v124, v120
    v_mov_b32 v125, v121
    v_mov_b32 v126, v122
    v_mov_b32 v127, v123
    v_permlane16_swap_b32 v120, v124
    v_permlane16_swap_b32 v121, v125
    v_permlane16_swap_b32 v122, v126
    v_permlane16_swap_b32 v123, v127
    v_pk_add_f32 v[120:121], v[120:121], v[124:125]
    v_pk_add_f32 v[122:123], v[122:123], v[126:127]
    v_mov_b32 v124, v120
    v_mov_b32 v125, v121
    v_mov_b32 v126, v122
    v_mov_b32 v127, v123
    v_permlane32_swap_b32 v120, v124
    v_permlane32_swap_b32 v121, v125
    v_permlane32_swap_b32 v122, v126
    v_permlane32_swap_b32 v123, v127
    v_pk_add_f32 v[120:121], v[120:121], v[124:125]
    v_pk_add_f32 v[122:123], v[122:123], v[126:127]
    v_cvt_pk_bf16_f32 v120, v120, v121
    v_cvt_pk_bf16_f32 v121, v122, v123
    v_mov_b32 v122, v120
    v_mov_b32 v123, v121
    v_and_b32 v5, 7, v1
    v_lshlrev_b32 v5, 7, v5
    v_lshrrev_b32 v6, 3, v1
    v_lshl_add_u32 v5, v6, 4, v5
    ds_write_b128 v5, v[120:123] offset:58368
fused_kernel_pz10:
    s_waitcnt lgkmcnt(0)
    s_barrier
    v_lshlrev_b32 v5, 3, v1
    ds_read_b64 v[136:137], v5 offset:57344
    ds_read_b64 v[138:139], v5 offset:57856
    ds_read_b64 v[140:141], v5 offset:58368
    ds_read_b64 v[142:143], v5 offset:58880
    s_waitcnt lgkmcnt(0)
    v_mfma_f32_16x16x16_bf16 v[144:147], v[136:137], v[12:13], 0
    v_mfma_f32_16x16x16_bf16 v[152:155], v[140:141], v[12:13], 0
    v_mfma_f32_16x16x16_bf16 v[148:151], v[138:139], v[14:15], 0
    v_mfma_f32_16x16x16_bf16 v[156:159], v[142:143], v[14:15], 0
    s_nop 5
    v_cvt_pk_bf16_f32 v76, 0, v152
    v_add_f32 v76, 0x358637bd, v76
    v_cvt_pk_bf16_f32 v76, 0, v76
    v_rcp_f32 v76, v76
    v_cvt_pk_bf16_f32 v78, 0, v144
    v_cvt_pk_bf16_f32 v79, 0, v145
    v_cvt_pk_bf16_f32 v80, 0, v146
    v_cvt_pk_bf16_f32 v81, 0, v147
    v_mul_f32 v78, v78, v76
    v_mul_f32 v79, v79, v76
    v_mul_f32 v80, v80, v76
    v_mul_f32 v81, v81, v76
    v_cvt_pk_bf16_f32 v160, v78, v79
    v_cvt_pk_bf16_f32 v161, v80, v81
    v_cvt_pk_bf16_f32 v84, 0, v156
    v_add_f32 v84, 0x358637bd, v84
    v_cvt_pk_bf16_f32 v84, 0, v84
    v_rcp_f32 v84, v84
    v_cvt_pk_bf16_f32 v86, 0, v148
    v_cvt_pk_bf16_f32 v87, 0, v149
    v_cvt_pk_bf16_f32 v88, 0, v150
    v_cvt_pk_bf16_f32 v89, 0, v151
    v_mul_f32 v86, v86, v84
    v_mul_f32 v87, v87, v84
    v_mul_f32 v88, v88, v84
    v_mul_f32 v89, v89, v84
    v_cvt_pk_bf16_f32 v162, v86, v87
    v_cvt_pk_bf16_f32 v163, v88, v89
    s_lshl_b32 s50, s57, 4
    s_add_u32 s50, s50, s56
    s_lshl_b32 s50, s50, 10
    s_add_u32 s50, s50, s72
    s_mul_i32 s51, s55, 327680
    s_add_u32 s50, s50, s51
    s_add_u32 s50, s50, 0x40000
    buffer_store_dwordx4 v[160:163], v3, s[40:43], s50 offen
    s_mul_i32 s62, s58, 16384
    s_mul_i32 s51, s60, 8192
    s_add_u32 s62, s62, s51
    s_add_u32 s62, s62, s72
    s_bfe_u32 s51, s46, 0x10001
    s_mul_i32 s51, s51, 327680
    s_add_u32 s62, s62, s51
    s_add_u32 s62, s62, 0x40000
    s_waitcnt vmcnt(0)
    s_barrier
    s_cmp_ge_u32 s44, 4
    s_cbranch_scc1 fused_kernel_tw11
    s_mul_i32 s51, s44, 5
    s_lshr_b32 s51, 0x5a928, s51
    s_and_b32 s51, s51, 31
    s_lshl_b32 s51, s51, 13
    v_add_u32 v76, s51, v24
    v_add_u32 v77, s51, v25
    v_add_u32 v78, s51, v26
    v_add_u32 v79, s51, v27
    v_add_u32 v80, s51, v28
    v_add_u32 v81, s51, v29
    v_add_u32 v82, s51, v30
    v_add_u32 v83, s51, v3
    ds_read_b64_tr_b16 v[104:105], v76 offset:0
    ds_read_b64_tr_b16 v[106:107], v76 offset:4096
    ds_read_b64_tr_b16 v[108:109], v77 offset:0
    ds_read_b64_tr_b16 v[110:111], v77 offset:4096
    ds_read_b64_tr_b16 v[112:113], v78 offset:0
    ds_read_b64_tr_b16 v[114:115], v78 offset:4096
    ds_read_b64_tr_b16 v[116:117], v79 offset:0
    ds_read_b64_tr_b16 v[118:119], v79 offset:4096
    ds_read_b64_tr_b16 v[120:121], v80 offset:0
    ds_read_b64_tr_b16 v[122:123], v80 offset:4096
    ds_read_b64_tr_b16 v[124:125], v81 offset:0
    ds_read_b64_tr_b16 v[126:127], v81 offset:4096
    ds_read_b64_tr_b16 v[128:129], v82 offset:0
    ds_read_b64_tr_b16 v[130:131], v82 offset:4096
    s_waitcnt lgkmcnt(0)
    ds_write_b128 v83, v[104:107] offset:0
    ds_write_b128 v83, v[108:111] offset:1024
    ds_write_b128 v83, v[112:115] offset:2048
    ds_write_b128 v83, v[116:119] offset:3072
    ds_write_b128 v83, v[120:123] offset:4096
    ds_write_b128 v83, v[124:127] offset:5120
    ds_write_b128 v83, v[128:131] offset:6144
    s_cmp_lg_u32 s44, 0
    s_cbranch_scc1 fused_kernel_bt12
    v_lshlrev_b32 v160, 16, v36
    v_and_b32 v161, 0xffff0000, v36
    v_lshlrev_b32 v162, 16, v37
    v_and_b32 v163, 0xffff0000, v37
    s_mov_b64 exec, 0xfffffff
    ds_write_b128 v83, v[160:163] offset:7168
    s_mov_b64 exec, -1
fused_kernel_bt12:
    s_waitcnt lgkmcnt(0)
fused_kernel_tw11:
    s_barrier
    buffer_load_dwordx4 v[104:107], v3, s[40:43], s62 offen sc1
    buffer_load_dwordx4 v[108:111], v3, s[40:43], s62 offen offset:1024 sc1
    buffer_load_dwordx4 v[112:115], v3, s[40:43], s62 offen offset:2048 sc1
    buffer_load_dwordx4 v[116:119], v3, s[40:43], s62 offen offset:3072 sc1
    s_add_u32 s62, s62, 4096
    buffer_load_dwordx4 v[120:123], v3, s[40:43], s62 offen sc1
    buffer_load_dwordx4 v[124:127], v3, s[40:43], s62 offen offset:1024 sc1
    buffer_load_dwordx4 v[128:131], v3, s[40:43], s62 offen offset:2048 sc1
    buffer_load_dwordx4 v[132:135], v3, s[40:43], s62 offen offset:3072 sc1
    v_lshrrev_b32 v5, 1, v2
    v_lshl_add_u32 v5, v5, 1, v1
    v_and_b32 v5, 15, v5
    v_lshlrev_b32 v5, 4, v5
    v_lshl_add_u32 v5, v2, 8, v5
    s_lshl_b32 s51, s44, 13
    s_add_u32 s51, s51, 98304
    v_add_u32 v5, s51, v5
    s_movk_i32 s51, 0xff
    v_add_u32 v6, 64, v5
    v_bfi_b32 v6, s51, v6, v5
    v_add_u32 v7, 0x80, v5
    v_bfi_b32 v7, s51, v7, v5
    v_add_u32 v8, 0xc0, v5
    v_bfi_b32 v8, s51, v8, v5
    s_cmp_eq_u32 s60, 0
    s_cbranch_scc1 fused_kernel_cb13
    s_barrier
fused_kernel_cb13:
    ds_read_b64_tr_b16 v[76:77], v31 offset:32768
    ds_read_b64_tr_b16 v[78:79], v31 offset:34816
    ds_read_b64_tr_b16 v[80:81], v32 offset:32768
    ds_read_b64_tr_b16 v[82:83], v32 offset:34816
    ds_read_b64_tr_b16 v[84:85], v33 offset:32768
    ds_read_b64_tr_b16 v[86:87], v33 offset:34816
    ds_read_b64_tr_b16 v[88:89], v34 offset:32768
    ds_read_b64_tr_b16 v[90:91], v34 offset:34816
    ds_read_b64_tr_b16 v[92:93], v31 offset:40960
    ds_read_b64_tr_b16 v[94:95], v31 offset:43008
    ds_read_b64_tr_b16 v[96:97], v32 offset:40960
    ds_read_b64_tr_b16 v[98:99], v32 offset:43008
    ds_read_b64_tr_b16 v[100:101], v33 offset:40960
    ds_read_b64_tr_b16 v[102:103], v33 offset:43008
    s_waitcnt lgkmcnt(12)
    s_waitcnt vmcnt(7)
    v_mfma_f32_16x16x32_bf16 v[48:51], v[76:79], v[104:107], 0
    ds_read_b64_tr_b16 v[76:77], v34 offset:40960
    ds_read_b64_tr_b16 v[78:79], v34 offset:43008
    s_waitcnt lgkmcnt(12)
    v_mfma_f32_16x16x32_bf16 v[52:55], v[80:83], v[104:107], 0
    ds_read_b64_tr_b16 v[80:81], v31 offset:49152
    ds_read_b64_tr_b16 v[82:83], v31 offset:51200
    s_waitcnt lgkmcnt(12)
    v_mfma_f32_16x16x32_bf16 v[56:59], v[84:87], v[104:107], 0
    ds_read_b64_tr_b16 v[84:85], v32 offset:49152
    ds_read_b64_tr_b16 v[86:87], v32 offset:51200
    s_waitcnt lgkmcnt(12)
    v_mfma_f32_16x16x32_bf16 v[60:63], v[88:91], v[104:107], 0
    ds_read_b64_tr_b16 v[88:89], v33 offset:49152
    ds_read_b64_tr_b16 v[90:91], v33 offset:51200
    s_waitcnt lgkmcnt(12)
    s_waitcnt vmcnt(6)
    v_mfma_f32_16x16x32_bf16 v[48:51], v[92:95], v[108:111], v[48:51]
    ds_read_b64_tr_b16 v[92:93], v34 offset:49152
    ds_read_b64_tr_b16 v[94:95], v34 offset:51200
    s_waitcnt lgkmcnt(12)
    v_mfma_f32_16x16x32_bf16 v[52:55], v[96:99], v[108:111], v[52:55]
    ds_read_b64_tr_b16 v[96:97], v31 offset:57344
    ds_read_b64_tr_b16 v[98:99], v31 offset:59392
    s_waitcnt lgkmcnt(12)
    v_mfma_f32_16x16x32_bf16 v[56:59], v[100:103], v[108:111], v[56:59]
    ds_read_b64_tr_b16 v[100:101], v32 offset:57344
    ds_read_b64_tr_b16 v[102:103], v32 offset:59392
    s_waitcnt lgkmcnt(12)
    v_mfma_f32_16x16x32_bf16 v[60:63], v[76:79], v[108:111], v[60:63]
    ds_read_b64_tr_b16 v[76:77], v33 offset:57344
    ds_read_b64_tr_b16 v[78:79], v33 offset:59392
    s_waitcnt lgkmcnt(12)
    s_waitcnt vmcnt(5)
    v_mfma_f32_16x16x32_bf16 v[48:51], v[80:83], v[112:115], v[48:51]
    ds_read_b64_tr_b16 v[80:81], v34 offset:57344
    ds_read_b64_tr_b16 v[82:83], v34 offset:59392
    s_waitcnt lgkmcnt(12)
    v_mfma_f32_16x16x32_bf16 v[52:55], v[84:87], v[112:115], v[52:55]
    ds_read_b64_tr_b16 v[84:85], v40 offset:0
    ds_read_b64_tr_b16 v[86:87], v40 offset:2048
    s_waitcnt lgkmcnt(12)
    v_mfma_f32_16x16x32_bf16 v[56:59], v[88:91], v[112:115], v[56:59]
    ds_read_b64_tr_b16 v[88:89], v41 offset:0
    ds_read_b64_tr_b16 v[90:91], v41 offset:2048
    s_waitcnt lgkmcnt(12)
    v_mfma_f32_16x16x32_bf16 v[60:63], v[92:95], v[112:115], v[60:63]
    ds_read_b64_tr_b16 v[92:93], v42 offset:0
    ds_read_b64_tr_b16 v[94:95], v42 offset:2048
    s_waitcnt lgkmcnt(12)
    s_waitcnt vmcnt(4)
    v_mfma_f32_16x16x32_bf16 v[48:51], v[96:99], v[116:119], v[48:51]
    ds_read_b64_tr_b16 v[96:97], v43 offset:0
    ds_read_b64_tr_b16 v[98:99], v43 offset:2048
    s_waitcnt lgkmcnt(12)
    v_mfma_f32_16x16x32_bf16 v[52:55], v[100:103], v[116:119], v[52:55]
    ds_read_b64_tr_b16 v[100:101], v40 offset:8192
    ds_read_b64_tr_b16 v[102:103], v40 offset:10240
    s_waitcnt lgkmcnt(12)
    v_mfma_f32_16x16x32_bf16 v[56:59], v[76:79], v[116:119], v[56:59]
    ds_read_b64_tr_b16 v[76:77], v41 offset:8192
    ds_read_b64_tr_b16 v[78:79], v41 offset:10240
    s_waitcnt lgkmcnt(12)
    v_mfma_f32_16x16x32_bf16 v[60:63], v[80:83], v[116:119], v[60:63]
    ds_read_b64_tr_b16 v[80:81], v42 offset:8192
    ds_read_b64_tr_b16 v[82:83], v42 offset:10240
    s_waitcnt lgkmcnt(12)
    s_waitcnt vmcnt(3)
    v_mfma_f32_16x16x32_bf16 v[48:51], v[84:87], v[120:123], v[48:51]
    ds_read_b64_tr_b16 v[84:85], v43 offset:8192
    ds_read_b64_tr_b16 v[86:87], v43 offset:10240
    s_waitcnt lgkmcnt(12)
    v_mfma_f32_16x16x32_bf16 v[52:55], v[88:91], v[120:123], v[52:55]
    ds_read_b64_tr_b16 v[88:89], v40 offset:16384
    ds_read_b64_tr_b16 v[90:91], v40 offset:18432
    s_waitcnt lgkmcnt(12)
    v_mfma_f32_16x16x32_bf16 v[56:59], v[92:95], v[120:123], v[56:59]
    ds_read_b64_tr_b16 v[92:93], v41 offset:16384
    ds_read_b64_tr_b16 v[94:95], v41 offset:18432
    s_waitcnt lgkmcnt(12)
    v_mfma_f32_16x16x32_bf16 v[60:63], v[96:99], v[120:123], v[60:63]
    ds_read_b64_tr_b16 v[96:97], v42 offset:16384
    ds_read_b64_tr_b16 v[98:99], v42 offset:18432
    s_waitcnt lgkmcnt(12)
    s_waitcnt vmcnt(2)
    v_mfma_f32_16x16x32_bf16 v[48:51], v[100:103], v[124:127], v[48:51]
    ds_read_b64_tr_b16 v[100:101], v43 offset:16384
    ds_read_b64_tr_b16 v[102:103], v43 offset:18432
    s_waitcnt lgkmcnt(12)
    v_mfma_f32_16x16x32_bf16 v[52:55], v[76:79], v[124:127], v[52:55]
    ds_read_b64_tr_b16 v[76:77], v40 offset:24576
    ds_read_b64_tr_b16 v[78:79], v40 offset:26624
    s_waitcnt lgkmcnt(12)
    v_mfma_f32_16x16x32_bf16 v[56:59], v[80:83], v[124:127], v[56:59]
    ds_read_b64_tr_b16 v[80:81], v41 offset:24576
    ds_read_b64_tr_b16 v[82:83], v41 offset:26624
    s_waitcnt lgkmcnt(12)
    v_mfma_f32_16x16x32_bf16 v[60:63], v[84:87], v[124:127], v[60:63]
    ds_read_b64_tr_b16 v[84:85], v42 offset:24576
    ds_read_b64_tr_b16 v[86:87], v42 offset:26624
    s_waitcnt lgkmcnt(12)
    s_waitcnt vmcnt(1)
    v_mfma_f32_16x16x32_bf16 v[48:51], v[88:91], v[128:131], v[48:51]
    ds_read_b64_tr_b16 v[88:89], v43 offset:24576
    ds_read_b64_tr_b16 v[90:91], v43 offset:26624
    s_waitcnt lgkmcnt(12)
    v_mfma_f32_16x16x32_bf16 v[52:55], v[92:95], v[128:131], v[52:55]
    s_waitcnt lgkmcnt(10)
    v_mfma_f32_16x16x32_bf16 v[56:59], v[96:99], v[128:131], v[56:59]
    s_waitcnt lgkmcnt(8)
    v_mfma_f32_16x16x32_bf16 v[60:63], v[100:103], v[128:131], v[60:63]
    s_waitcnt lgkmcnt(6)
    s_waitcnt vmcnt(0)
    v_mfma_f32_16x16x32_bf16 v[48:51], v[76:79], v[132:135], v[48:51]
    s_waitcnt lgkmcnt(4)
    v_mfma_f32_16x16x32_bf16 v[52:55], v[80:83], v[132:135], v[52:55]
    s_waitcnt lgkmcnt(2)
    v_mfma_f32_16x16x32_bf16 v[56:59], v[84:87], v[132:135], v[56:59]
    s_waitcnt lgkmcnt(0)
    v_mfma_f32_16x16x32_bf16 v[60:63], v[88:91], v[132:135], v[60:63]
    s_cmp_eq_u32 s60, 1
    s_cbranch_scc1 fused_kernel_cb14
    s_barrier
fused_kernel_cb14:
    ds_write_b128 v5, v[48:51] offset:0
    ds_write_b128 v6, v[52:55] offset:1024
    s_nop 0
    ds_write_b128 v7, v[56:59] offset:2048
    s_nop 0
    ds_write_b128 v8, v[60:63] offset:3072
    v_and_b32 v76, 7, v1
    v_lshrrev_b32 v77, 3, v1
    s_and_b32 s51, s44, 1
    s_lshl_b32 s51, s51, 3
    v_add_u32 v77, s51, v77
    v_lshl_add_u32 v77, v76, 1, v77
    v_and_b32 v77, 15, v77
    v_lshlrev_b32 v77, 4, v77
    v_lshl_add_u32 v77, v76, 9, v77
    s_lshr_b32 s51, s44, 1
    s_lshl_b32 s51, s51, 13
    s_add_u32 s51, s51, 98304
    v_add_u32 v77, s51, v77
    s_waitcnt lgkmcnt(0)
    s_barrier
    ds_read_b128 v[48:51], v77 offset:0
    ds_read_b128 v[52:55], v77 offset:256
    ds_read_b128 v[56:59], v77 offset:32768
    ds_read_b128 v[60:63], v77 offset:33024
    s_waitcnt lgkmcnt(0)
    v_pk_add_f32 v[48:49], v[48:49], v[56:57]
    v_pk_add_f32 v[50:51], v[50:51], v[58:59]
    v_pk_add_f32 v[52:53], v[52:53], v[60:61]
    v_pk_add_f32 v[54:55], v[54:55], v[62:63]
    v_cvt_pk_bf16_f32 v76, 0, v48
    v_cvt_pk_bf16_f32 v77, 0, v49
    v_cvt_pk_bf16_f32 v78, 0, v50
    v_cvt_pk_bf16_f32 v79, 0, v51
    v_lshlrev_b32 v80, 16, v20
    v_and_b32 v81, 0xffff0000, v20
    v_lshlrev_b32 v82, 16, v21
    v_and_b32 v83, 0xffff0000, v21
    v_pk_add_f32 v[76:77], v[76:77], v[80:81]
    v_pk_add_f32 v[78:79], v[78:79], v[82:83]
    v_cvt_pk_bf16_f32 v16, v76, v77
    v_cvt_pk_bf16_f32 v17, v78, v79
    v_cvt_pk_bf16_f32 v76, 0, v52
    v_cvt_pk_bf16_f32 v77, 0, v53
    v_cvt_pk_bf16_f32 v78, 0, v54
    v_cvt_pk_bf16_f32 v79, 0, v55
    v_lshlrev_b32 v80, 16, v22
    v_and_b32 v81, 0xffff0000, v22
    v_lshlrev_b32 v82, 16, v23
    v_and_b32 v83, 0xffff0000, v23
    v_pk_add_f32 v[76:77], v[76:77], v[80:81]
    v_pk_add_f32 v[78:79], v[78:79], v[82:83]
    v_cvt_pk_bf16_f32 v18, v76, v77
    v_cvt_pk_bf16_f32 v19, v78, v79
    buffer_store_dwordx4 v[16:19], v9, s[40:43], s72 offen
    v_lshrrev_b32 v5, 5, v1
    v_and_b32 v6, 31, v1
    v_lshlrev_b32 v20, 10, v5
    v_lshl_add_u32 v20, v6, 4, v20
    v_lshrrev_b32 v38, 2, v6
    v_mul_u32_u24 v38, 1040, v38
    v_bfe_u32 v8, v6, 1, 1
    v_lshl_add_u32 v38, v8, 3, v38
    v_and_b32 v8, 1, v6
    v_lshl_add_u32 v38, v8, 9, v38
    v_add_u32 v38, 0x18000, v38
    s_lshl_b32 s51, s44, 1
    v_add_u32 v5, s51, v5
    v_lshl_add_u32 v5, v8, 3, v5
    v_add_u32 v6, 4, v5
    v_and_b32 v5, 15, v5
    v_and_b32 v6, 15, v6
    v_lshl_add_u32 v21, v6, 4, v38
    v_lshl_add_u32 v38, v5, 4, v38
    s_lshl_b32 s63, s45, 4
    s_add_u32 s63, s63, s46
    s_lshl_b32 s63, s63, 14
    s_lshl_b32 s52, s44, 11
    s_add_u32 s63, s63, s52
    s_add_u32 s63, s63, s72
    s_mul_i32 s51, s44, 2080
    s_add_u32 s51, s51, 98304
    v_lshl_add_u32 v39, v2, 2, v1
    v_and_b32 v39, 15, v39
    v_lshlrev_b32 v39, 4, v39
    v_lshl_add_u32 v39, v2, 8, v39
    v_add_u32 v39, s51, v39
    s_waitcnt vmcnt(0)
    s_barrier
    s_cmp_ge_u32 s44, 6
    s_cbranch_scc1 fused_kernel_tw15
    s_mul_i32 s51, s44, 5
    s_lshr_b32 s51, 0x41018a4, s51
    s_and_b32 s51, s51, 31
    s_lshl_b32 s51, s51, 13
    v_add_u32 v76, s51, v24
    v_add_u32 v77, s51, v25
    v_add_u32 v78, s51, v26
    v_add_u32 v79, s51, v27
    v_add_u32 v80, s51, v28
    v_add_u32 v81, s51, v29
    v_add_u32 v82, s51, v30
    v_add_u32 v83, s51, v3
    ds_read_b64_tr_b16 v[104:105], v76 offset:0
    ds_read_b64_tr_b16 v[106:107], v76 offset:4096
    ds_read_b64_tr_b16 v[108:109], v77 offset:0
    ds_read_b64_tr_b16 v[110:111], v77 offset:4096
    ds_read_b64_tr_b16 v[112:113], v78 offset:0
    ds_read_b64_tr_b16 v[114:115], v78 offset:4096
    ds_read_b64_tr_b16 v[116:117], v79 offset:0
    ds_read_b64_tr_b16 v[118:119], v79 offset:4096
    ds_read_b64_tr_b16 v[120:121], v80 offset:0
    ds_read_b64_tr_b16 v[122:123], v80 offset:4096
    ds_read_b64_tr_b16 v[124:125], v81 offset:0
    ds_read_b64_tr_b16 v[126:127], v81 offset:4096
    ds_read_b64_tr_b16 v[128:129], v82 offset:0
    ds_read_b64_tr_b16 v[130:131], v82 offset:4096
    s_waitcnt lgkmcnt(0)
    ds_write_b128 v83, v[104:107] offset:0
    ds_write_b128 v83, v[108:111] offset:1024
    ds_write_b128 v83, v[112:115] offset:2048
    ds_write_b128 v83, v[116:119] offset:3072
    ds_write_b128 v83, v[120:123] offset:4096
    ds_write_b128 v83, v[124:127] offset:5120
    ds_write_b128 v83, v[128:131] offset:6144
    s_waitcnt lgkmcnt(0)
fused_kernel_tw15:
    s_cmp_ge_u32 s46, 16
    s_cbranch_scc1 fused_kernel_free16
    s_barrier
    buffer_load_dwordx4 v[104:107], v20, s[40:43], s63 offen sc1
    buffer_load_dwordx4 v[108:111], v20, s[40:43], s63 offen offset:512 sc1
    s_barrier
    s_waitcnt vmcnt(0)
    v_dot2_f32_bf16 v112, v104, s54, 0
    v_dot2_f32_bf16 v113, v105, s54, 0
    v_dot2_f32_bf16 v114, v104, v104, 0
    v_dot2_f32_bf16 v115, v105, v105, 0
    v_dot2_f32_bf16 v112, v106, s54, v112
    v_dot2_f32_bf16 v113, v107, s54, v113
    v_dot2_f32_bf16 v114, v106, v106, v114
    v_dot2_f32_bf16 v115, v107, v107, v115
    v_dot2_f32_bf16 v112, v108, s54, v112
    v_dot2_f32_bf16 v113, v109, s54, v113
    v_dot2_f32_bf16 v114, v108, v108, v114
    v_dot2_f32_bf16 v115, v109, v109, v115
    v_dot2_f32_bf16 v112, v110, s54, v112
    v_dot2_f32_bf16 v113, v111, s54, v113
    v_dot2_f32_bf16 v114, v110, v110, v114
    v_dot2_f32_bf16 v115, v111, v111, v115
    v_lshlrev_b32 v120, 16, v104
    v_and_b32 v121, 0xffff0000, v104
    v_lshlrev_b32 v122, 16, v105
    v_and_b32 v123, 0xffff0000, v105
    v_lshlrev_b32 v124, 16, v106
    v_and_b32 v125, 0xffff0000, v106
    v_lshlrev_b32 v126, 16, v107
    v_and_b32 v127, 0xffff0000, v107
    v_lshlrev_b32 v128, 16, v108
    v_and_b32 v129, 0xffff0000, v108
    v_lshlrev_b32 v130, 16, v109
    v_and_b32 v131, 0xffff0000, v109
    v_lshlrev_b32 v132, 16, v110
    v_and_b32 v133, 0xffff0000, v110
    v_lshlrev_b32 v134, 16, v111
    v_and_b32 v135, 0xffff0000, v111
    v_add_f32 v112, v112, v113
    v_add_f32 v114, v114, v115
    s_nop 0
    v_add_f32_dpp v112, v112, v112 quad_perm:[1,0,3,2] row_mask:0xf bank_mask:0xf
    v_add_f32_dpp v114, v114, v114 quad_perm:[1,0,3,2] row_mask:0xf bank_mask:0xf
    s_nop 0
    v_add_f32_dpp v112, v112, v112 quad_perm:[2,3,0,1] row_mask:0xf bank_mask:0xf
    v_add_f32_dpp v114, v114, v114 quad_perm:[2,3,0,1] row_mask:0xf bank_mask:0xf
    s_nop 0
    v_add_f32_dpp v112, v112, v112 row_half_mirror row_mask:0xf bank_mask:0xf
    v_add_f32_dpp v114, v114, v114 row_half_mirror row_mask:0xf bank_mask:0xf
    s_nop 0
    v_add_f32_dpp v112, v112, v112 row_mirror row_mask:0xf bank_mask:0xf
    v_add_f32_dpp v114, v114, v114 row_mirror row_mask:0xf bank_mask:0xf
    v_mov_b32 v113, v112
    v_mov_b32 v115, v114
    s_nop 0
    v_permlane16_swap_b32 v112, v113
    v_permlane16_swap_b32 v114, v115
    v_add_f32 v112, v112, v113
    v_add_f32 v114, v114, v115
    v_mul_f32 v112, 0x3b000000, v112
    v_mul_f32 v114, 0x3b000000, v114
    v_cvt_pk_bf16_f32 v117, 0, v112
    v_mul_f32 v116, v112, v112
    v_sub_f32 v118, 0, v117
    v_sub_f32 v119, 0, v117
    v_sub_f32 v114, v114, v116
    v_max_f32 v114, 0, v114
    v_cvt_pk_bf16_f32 v114, 0, v114
    v_pk_add_f32 v[120:121], v[120:121], v[118:119]
    v_pk_add_f32 v[122:123], v[122:123], v[118:119]
    v_pk_add_f32 v[124:125], v[124:125], v[118:119]
    v_pk_add_f32 v[126:127], v[126:127], v[118:119]
    v_pk_add_f32 v[128:129], v[128:129], v[118:119]
    v_pk_add_f32 v[130:131], v[130:131], v[118:119]
    v_pk_add_f32 v[132:133], v[132:133], v[118:119]
    v_pk_add_f32 v[134:135], v[134:135], v[118:119]
    v_add_f32 v114, 0x3727c5ac, v114
    v_cvt_pk_bf16_f32 v114, 0, v114
    v_sqrt_f32 v114, v114
    v_cvt_pk_bf16_f32 v120, 0, v120
    v_cvt_pk_bf16_f32 v121, 0, v121
    v_cvt_pk_bf16_f32 v122, 0, v122
    v_cvt_pk_bf16_f32 v123, 0, v123
    v_cvt_pk_bf16_f32 v124, 0, v124
    v_cvt_pk_bf16_f32 v125, 0, v125
    v_cvt_pk_bf16_f32 v126, 0, v126
    v_cvt_pk_bf16_f32 v127, 0, v127
    v_cvt_pk_bf16_f32 v114, 0, v114
    v_rcp_f32 v118, v114
    v_rcp_f32 v119, v114
    v_cvt_pk_bf16_f32 v128, 0, v128
    v_cvt_pk_bf16_f32 v129, 0, v129
    v_cvt_pk_bf16_f32 v130, 0, v130
    v_cvt_pk_bf16_f32 v131, 0, v131
    v_cvt_pk_bf16_f32 v132, 0, v132
    v_cvt_pk_bf16_f32 v133, 0, v133
    v_cvt_pk_bf16_f32 v134, 0, v134
    v_cvt_pk_bf16_f32 v135, 0, v135
    v_pk_mul_f32 v[120:121], v[120:121], v[118:119]
    v_pk_mul_f32 v[122:123], v[122:123], v[118:119]
    v_pk_mul_f32 v[124:125], v[124:125], v[118:119]
    v_pk_mul_f32 v[126:127], v[126:127], v[118:119]
    v_pk_mul_f32 v[128:129], v[128:129], v[118:119]
    v_pk_mul_f32 v[130:131], v[130:131], v[118:119]
    v_pk_mul_f32 v[132:133], v[132:133], v[118:119]
    v_pk_mul_f32 v[134:135], v[134:135], v[118:119]
    v_cvt_pk_bf16_f32 v120, 0, v120
    v_cvt_pk_bf16_f32 v121, 0, v121
    v_cvt_pk_bf16_f32 v122, 0, v122
    v_cvt_pk_bf16_f32 v123, 0, v123
    v_cvt_pk_bf16_f32 v124, 0, v124
    v_cvt_pk_bf16_f32 v125, 0, v125
    v_cvt_pk_bf16_f32 v126, 0, v126
    v_cvt_pk_bf16_f32 v127, 0, v127
    v_cvt_pk_bf16_f32 v128, 0, v128
    v_cvt_pk_bf16_f32 v129, 0, v129
    v_cvt_pk_bf16_f32 v130, 0, v130
    v_cvt_pk_bf16_f32 v131, 0, v131
    v_cvt_pk_bf16_f32 v132, 0, v132
    v_cvt_pk_bf16_f32 v133, 0, v133
    v_cvt_pk_bf16_f32 v134, 0, v134
    v_cvt_pk_bf16_f32 v135, 0, v135
    v_pk_add_f32 v[112:113], v[120:121], v[122:123]
    v_pk_mul_f32 v[114:115], v[120:121], v[120:121]
    v_pk_fma_f32 v[114:115], v[122:123], v[122:123], v[114:115]
    v_pk_add_f32 v[112:113], v[112:113], v[124:125]
    v_pk_fma_f32 v[114:115], v[124:125], v[124:125], v[114:115]
    v_pk_add_f32 v[112:113], v[112:113], v[126:127]
    v_pk_fma_f32 v[114:115], v[126:127], v[126:127], v[114:115]
    v_pk_add_f32 v[112:113], v[112:113], v[128:129]
    v_pk_fma_f32 v[114:115], v[128:129], v[128:129], v[114:115]
    v_pk_add_f32 v[112:113], v[112:113], v[130:131]
    v_pk_fma_f32 v[114:115], v[130:131], v[130:131], v[114:115]
    v_pk_add_f32 v[112:113], v[112:113], v[132:133]
    v_pk_fma_f32 v[114:115], v[132:133], v[132:133], v[114:115]
    v_pk_add_f32 v[112:113], v[112:113], v[134:135]
    v_pk_fma_f32 v[114:115], v[134:135], v[134:135], v[114:115]
    v_add_f32 v112, v112, v113
    v_add_f32 v114, v114, v115
    s_nop 0
    v_add_f32_dpp v112, v112, v112 quad_perm:[1,0,3,2] row_mask:0xf bank_mask:0xf
    v_add_f32_dpp v114, v114, v114 quad_perm:[1,0,3,2] row_mask:0xf bank_mask:0xf
    s_nop 0
    v_add_f32_dpp v112, v112, v112 quad_perm:[2,3,0,1] row_mask:0xf bank_mask:0xf
    v_add_f32_dpp v114, v114, v114 quad_perm:[2,3,0,1] row_mask:0xf bank_mask:0xf
    s_nop 0
    v_add_f32_dpp v112, v112, v112 row_half_mirror row_mask:0xf bank_mask:0xf
    v_add_f32_dpp v114, v114, v114 row_half_mirror row_mask:0xf bank_mask:0xf
    s_nop 0
    v_add_f32_dpp v112, v112, v112 row_mirror row_mask:0xf bank_mask:0xf
    v_add_f32_dpp v114, v114, v114 row_mirror row_mask:0xf bank_mask:0xf
    v_mov_b32 v113, v112
    v_mov_b32 v115, v114
    s_nop 0
    v_permlane16_swap_b32 v112, v113
    v_permlane16_swap_b32 v114, v115
    v_add_f32 v112, v112, v113
    v_add_f32 v114, v114, v115
    v_mul_f32 v112, 0x3b000000, v112
    v_mul_f32 v114, 0x3b000000, v114
    v_cvt_pk_bf16_f32 v117, 0, v112
    v_mul_f32 v116, v112, v112
    v_sub_f32 v118, 0, v117
    v_sub_f32 v119, 0, v117
    v_sub_f32 v114, v114, v116
    v_max_f32 v114, 0, v114
    v_cvt_pk_bf16_f32 v114, 0, v114
    v_pk_add_f32 v[120:121], v[120:121], v[118:119]
    v_pk_add_f32 v[122:123], v[122:123], v[118:119]
    v_pk_add_f32 v[124:125], v[124:125], v[118:119]
    v_pk_add_f32 v[126:127], v[126:127], v[118:119]
    v_pk_add_f32 v[128:129], v[128:129], v[118:119]
    v_pk_add_f32 v[130:131], v[130:131], v[118:119]
    v_pk_add_f32 v[132:133], v[132:133], v[118:119]
    v_pk_add_f32 v[134:135], v[134:135], v[118:119]
    v_add_f32 v114, 0x3727c5ac, v114
    v_cvt_pk_bf16_f32 v114, 0, v114
    v_sqrt_f32 v114, v114
    v_cvt_pk_bf16_f32 v120, 0, v120
    v_cvt_pk_bf16_f32 v121, 0, v121
    v_cvt_pk_bf16_f32 v122, 0, v122
    v_cvt_pk_bf16_f32 v123, 0, v123
    v_cvt_pk_bf16_f32 v124, 0, v124
    v_cvt_pk_bf16_f32 v125, 0, v125
    v_cvt_pk_bf16_f32 v126, 0, v126
    v_cvt_pk_bf16_f32 v127, 0, v127
    v_cvt_pk_bf16_f32 v114, 0, v114
    v_rcp_f32 v118, v114
    v_rcp_f32 v119, v114
    v_cvt_pk_bf16_f32 v128, 0, v128
    v_cvt_pk_bf16_f32 v129, 0, v129
    v_cvt_pk_bf16_f32 v130, 0, v130
    v_cvt_pk_bf16_f32 v131, 0, v131
    v_cvt_pk_bf16_f32 v132, 0, v132
    v_cvt_pk_bf16_f32 v133, 0, v133
    v_cvt_pk_bf16_f32 v134, 0, v134
    v_cvt_pk_bf16_f32 v135, 0, v135
    v_pk_mul_f32 v[120:121], v[120:121], v[118:119]
    v_pk_mul_f32 v[122:123], v[122:123], v[118:119]
    v_pk_mul_f32 v[124:125], v[124:125], v[118:119]
    v_pk_mul_f32 v[126:127], v[126:127], v[118:119]
    v_pk_mul_f32 v[128:129], v[128:129], v[118:119]
    v_pk_mul_f32 v[130:131], v[130:131], v[118:119]
    v_pk_mul_f32 v[132:133], v[132:133], v[118:119]
    v_pk_mul_f32 v[134:135], v[134:135], v[118:119]
    v_cvt_pk_bf16_f32 v104, v120, v121
    v_cvt_pk_bf16_f32 v105, v122, v123
    v_cvt_pk_bf16_f32 v106, v124, v125
    v_cvt_pk_bf16_f32 v107, v126, v127
    v_cvt_pk_bf16_f32 v108, v128, v129
    v_cvt_pk_bf16_f32 v109, v130, v131
    v_cvt_pk_bf16_f32 v110, v132, v133
    v_cvt_pk_bf16_f32 v111, v134, v135
    ds_write_b64 v38, v[104:105] offset:0
    ds_write_b64 v21, v[106:107] offset:256
    ds_write_b64 v38, v[108:109] offset:8320
    ds_write_b64 v21, v[110:111] offset:8576
    s_waitcnt lgkmcnt(0)
    s_barrier
    ds_read_b128 v[104:107], v39
    ds_read_b128 v[108:111], v39 offset:1040
    s_waitcnt lgkmcnt(0)
    buffer_store_dwordx4 v[104:107], v3, s[40:43], s63 offen
    buffer_store_dwordx4 v[108:111], v3, s[40:43], s63 offen offset:1024
fused_kernel_free16:
    v_lshlrev_b32 v43, 4, v2
    v_add_u32 v43, 0x11c00, v43
    v_mov_b32 v42, 0xbdd2d3e8
    v_lshrrev_b32 v5, 3, v1
    v_and_b32 v6, 7, v1
    v_bfe_u32 v7, v5, 1, 2
    v_lshlrev_b32 v7, 1, v7
    v_xor_b32 v6, v6, v7
    v_lshlrev_b32 v4, 10, v5
    v_lshl_add_u32 v4, v6, 4, v4
    s_lshl_b32 s50, s59, 7
    v_add_u32 v4, s50, v4
    s_lshl_b32 s50, s57, 14
    s_add_u32 s50, s50, s72
    s_waitcnt vmcnt(0)
    s_barrier
    s_cmp_ge_u32 s44, 6
    s_cbranch_scc1 fused_kernel_tw17
    s_mul_i32 s51, s44, 5
    s_lshr_b32 s51, 0x2728c0e3, s51
    s_and_b32 s51, s51, 31
    s_lshl_b32 s51, s51, 13
    v_add_u32 v76, s51, v24
    v_add_u32 v77, s51, v25
    v_add_u32 v78, s51, v26
    v_add_u32 v79, s51, v27
    v_add_u32 v80, s51, v28
    v_add_u32 v81, s51, v29
    v_add_u32 v82, s51, v30
    v_add_u32 v83, s51, v3
    ds_read_b64_tr_b16 v[104:105], v76 offset:0
    ds_read_b64_tr_b16 v[106:107], v76 offset:4096
    ds_read_b64_tr_b16 v[108:109], v77 offset:0
    ds_read_b64_tr_b16 v[110:111], v77 offset:4096
    ds_read_b64_tr_b16 v[112:113], v78 offset:0
    ds_read_b64_tr_b16 v[114:115], v78 offset:4096
    ds_read_b64_tr_b16 v[116:117], v79 offset:0
    ds_read_b64_tr_b16 v[118:119], v79 offset:4096
    ds_read_b64_tr_b16 v[120:121], v80 offset:0
    ds_read_b64_tr_b16 v[122:123], v80 offset:4096
    ds_read_b64_tr_b16 v[124:125], v81 offset:0
    ds_read_b64_tr_b16 v[126:127], v81 offset:4096
    ds_read_b64_tr_b16 v[128:129], v82 offset:0
    ds_read_b64_tr_b16 v[130:131], v82 offset:4096
    s_waitcnt lgkmcnt(0)
    ds_write_b128 v83, v[104:107] offset:0
    ds_write_b128 v83, v[108:111] offset:1024
    ds_write_b128 v83, v[112:115] offset:2048
    ds_write_b128 v83, v[116:119] offset:3072
    ds_write_b128 v83, v[120:123] offset:4096
    ds_write_b128 v83, v[124:127] offset:5120
    ds_write_b128 v83, v[128:131] offset:6144
    s_waitcnt lgkmcnt(0)
fused_kernel_tw17:
    s_barrier
    buffer_load_dwordx4 v[104:107], v3, s[40:43], s50 offen sc1
    buffer_load_dwordx4 v[108:111], v3, s[40:43], s50 offen offset:1024 sc1
    buffer_load_dwordx4 v[112:115], v3, s[40:43], s50 offen offset:2048 sc1
    buffer_load_dwordx4 v[116:119], v3, s[40:43], s50 offen offset:3072 sc1
    s_add_u32 s50, s50, 4096
    buffer_load_dwordx4 v[120:123], v3, s[40:43], s50 offen sc1
    buffer_load_dwordx4 v[124:127], v3, s[40:43], s50 offen offset:1024 sc1
    buffer_load_dwordx4 v[128:131], v3, s[40:43], s50 offen offset:2048 sc1
    buffer_load_dwordx4 v[132:135], v3, s[40:43], s50 offen offset:3072 sc1
    s_add_u32 s50, s50, 4096
    buffer_load_dwordx4 v[136:139], v3, s[40:43], s50 offen sc1
    buffer_load_dwordx4 v[140:143], v3, s[40:43], s50 offen offset:1024 sc1
    buffer_load_dwordx4 v[144:147], v3, s[40:43], s50 offen offset:2048 sc1
    buffer_load_dwordx4 v[148:151], v3, s[40:43], s50 offen offset:3072 sc1
    s_add_u32 s50, s50, 4096
    buffer_load_dwordx4 v[152:155], v3, s[40:43], s50 offen sc1
    buffer_load_dwordx4 v[156:159], v3, s[40:43], s50 offen offset:1024 sc1
    buffer_load_dwordx4 v[160:163], v3, s[40:43], s50 offen offset:2048 sc1
    buffer_load_dwordx4 v[164:167], v3, s[40:43], s50 offen offset:3072 sc1
    s_lshl_b32 s51, s59, 7
    v_and_b32 v8, 7, v1
    v_lshlrev_b32 v8, 4, v8
    buffer_load_dwordx4 v[20:23], v8, s[28:31], s51 offen
    s_cmp_eq_u32 s60, 0
    s_cbranch_scc1 fused_kernel_cb18
    s_barrier
fused_kernel_cb18:
    s_mul_i32 s53, s57, 57344
    s_add_u32 s53, s53, s73
    s_mul_i32 s51, s56, 7
    s_lshr_b32 s51, s51, 1
    s_lshl_b32 s51, s51, 10
    s_add_u32 s53, s53, s51
    v_lshlrev_b32 v7, 7, v1
    s_cmp_eq_u32 s61, 3
    s_addc_u32 s64, s61, 0
    s_lshl_b32 s64, s64, 15
    s_lshl_b32 s65, s61, 13
    s_add_u32 s65, s65, 0x18000
    s_lshl_b32 s68, s61, 16
    ds_read_b128 v[76:79], v45 offset:0
    ds_read_b128 v[80:83], v45 offset:1024
    ds_read_b128 v[84:87], v45 offset:2048
    ds_read_b128 v[88:91], v45 offset:3072
    ds_read_b128 v[92:95], v45 offset:8192
    ds_read_b128 v[96:99], v45 offset:9216
    ds_read_b128 v[100:103], v43 offset:0
    ds_read_b128 v[12:15], v43 offset:64
    s_waitcnt lgkmcnt(7)
    s_waitcnt vmcnt(16)
    v_mfma_f32_16x16x32_bf16 v[48:51], v[76:79], v[104:107], 0
    ds_read_b128 v[76:79], v45 offset:10240
    s_waitcnt lgkmcnt(7)
    v_mfma_f32_16x16x32_bf16 v[52:55], v[80:83], v[104:107], 0
    ds_read_b128 v[80:83], v45 offset:11264
    s_waitcnt lgkmcnt(7)
    v_mfma_f32_16x16x32_bf16 v[56:59], v[84:87], v[104:107], 0
    ds_read_b128 v[84:87], v45 offset:16384
    s_waitcnt lgkmcnt(7)
    v_mfma_f32_16x16x32_bf16 v[60:63], v[88:91], v[104:107], 0
    ds_read_b128 v[88:91], v45 offset:17408
    s_waitcnt lgkmcnt(7)
    s_waitcnt vmcnt(15)
    v_mfma_f32_16x16x32_bf16 v[48:51], v[92:95], v[108:111], v[48:51]
    ds_read_b128 v[92:95], v45 offset:18432
    s_waitcnt lgkmcnt(7)
    v_mfma_f32_16x16x32_bf16 v[52:55], v[96:99], v[108:111], v[52:55]
    ds_read_b128 v[96:99], v45 offset:19456
    s_waitcnt lgkmcnt(5)
    v_mfma_f32_16x16x32_bf16 v[56:59], v[76:79], v[108:111], v[56:59]
    ds_read_b128 v[76:79], v45 offset:24576
    s_waitcnt lgkmcnt(5)
    v_mfma_f32_16x16x32_bf16 v[60:63], v[80:83], v[108:111], v[60:63]
    ds_read_b128 v[80:83], v45 offset:25600
    s_waitcnt lgkmcnt(5)
    s_waitcnt vmcnt(14)
    v_mfma_f32_16x16x32_bf16 v[48:51], v[84:87], v[112:115], v[48:51]
    ds_read_b128 v[84:87], v45 offset:26624
    s_waitcnt lgkmcnt(5)
    v_mfma_f32_16x16x32_bf16 v[52:55], v[88:91], v[112:115], v[52:55]
    ds_read_b128 v[88:91], v45 offset:27648
    s_waitcnt lgkmcnt(5)
    v_mfma_f32_16x16x32_bf16 v[56:59], v[92:95], v[112:115], v[56:59]
    ds_read_b128 v[92:95], v3 offset:32768
    s_waitcnt lgkmcnt(5)
    v_mfma_f32_16x16x32_bf16 v[60:63], v[96:99], v[112:115], v[60:63]
    ds_read_b128 v[96:99], v3 offset:33792
    s_waitcnt lgkmcnt(5)
    s_waitcnt vmcnt(13)
    v_mfma_f32_16x16x32_bf16 v[48:51], v[76:79], v[116:119], v[48:51]
    ds_read_b128 v[76:79], v3 offset:34816
    s_waitcnt lgkmcnt(5)
    v_mfma_f32_16x16x32_bf16 v[52:55], v[80:83], v[116:119], v[52:55]
    ds_read_b128 v[80:83], v3 offset:35840
    s_waitcnt lgkmcnt(5)
    v_mfma_f32_16x16x32_bf16 v[56:59], v[84:87], v[116:119], v[56:59]
    ds_read_b128 v[84:87], v3 offset:40960
    s_waitcnt lgkmcnt(5)
    v_mfma_f32_16x16x32_bf16 v[60:63], v[88:91], v[116:119], v[60:63]
    ds_read_b128 v[88:91], v3 offset:41984
    s_waitcnt lgkmcnt(5)
    s_waitcnt vmcnt(12)
    v_mfma_f32_16x16x32_bf16 v[48:51], v[92:95], v[120:123], v[48:51]
    ds_read_b128 v[92:95], v3 offset:43008
    s_waitcnt lgkmcnt(5)
    v_mfma_f32_16x16x32_bf16 v[52:55], v[96:99], v[120:123], v[52:55]
    ds_read_b128 v[96:99], v3 offset:44032
    s_waitcnt lgkmcnt(5)
    v_mfma_f32_16x16x32_bf16 v[56:59], v[76:79], v[120:123], v[56:59]
    ds_read_b128 v[76:79], v3 offset:49152
    s_waitcnt lgkmcnt(5)
    v_mfma_f32_16x16x32_bf16 v[60:63], v[80:83], v[120:123], v[60:63]
    ds_read_b128 v[80:83], v3 offset:50176
    s_waitcnt lgkmcnt(5)
    s_waitcnt vmcnt(11)
    v_mfma_f32_16x16x32_bf16 v[48:51], v[84:87], v[124:127], v[48:51]
    ds_read_b128 v[84:87], v3 offset:51200
    s_waitcnt lgkmcnt(5)
    v_mfma_f32_16x16x32_bf16 v[52:55], v[88:91], v[124:127], v[52:55]
    ds_read_b128 v[88:91], v3 offset:52224
    s_waitcnt lgkmcnt(5)
    v_mfma_f32_16x16x32_bf16 v[56:59], v[92:95], v[124:127], v[56:59]
    ds_read_b128 v[92:95], v3 offset:0
    s_waitcnt lgkmcnt(5)
    v_mfma_f32_16x16x32_bf16 v[60:63], v[96:99], v[124:127], v[60:63]
    ds_read_b128 v[96:99], v3 offset:1024
    s_waitcnt lgkmcnt(5)
    s_waitcnt vmcnt(10)
    v_mfma_f32_16x16x32_bf16 v[48:51], v[76:79], v[128:131], v[48:51]
    ds_read_b128 v[76:79], v3 offset:2048
    s_waitcnt lgkmcnt(5)
    v_mfma_f32_16x16x32_bf16 v[52:55], v[80:83], v[128:131], v[52:55]
    ds_read_b128 v[80:83], v3 offset:3072
    s_waitcnt lgkmcnt(5)
    v_mfma_f32_16x16x32_bf16 v[56:59], v[84:87], v[128:131], v[56:59]
    ds_read_b128 v[84:87], v3 offset:8192
    s_waitcnt lgkmcnt(5)
    v_mfma_f32_16x16x32_bf16 v[60:63], v[88:91], v[128:131], v[60:63]
    ds_read_b128 v[88:91], v3 offset:9216
    s_waitcnt lgkmcnt(5)
    s_waitcnt vmcnt(9)
    v_mfma_f32_16x16x32_bf16 v[48:51], v[92:95], v[132:135], v[48:51]
    ds_read_b128 v[92:95], v3 offset:10240
    s_waitcnt lgkmcnt(5)
    v_mfma_f32_16x16x32_bf16 v[52:55], v[96:99], v[132:135], v[52:55]
    ds_read_b128 v[96:99], v3 offset:11264
    s_waitcnt lgkmcnt(5)
    v_mfma_f32_16x16x32_bf16 v[56:59], v[76:79], v[132:135], v[56:59]
    ds_read_b128 v[76:79], v3 offset:16384
    s_waitcnt lgkmcnt(5)
    v_mfma_f32_16x16x32_bf16 v[60:63], v[80:83], v[132:135], v[60:63]
    ds_read_b128 v[80:83], v3 offset:17408
    s_waitcnt lgkmcnt(5)
    s_waitcnt vmcnt(8)
    v_mfma_f32_16x16x32_bf16 v[48:51], v[84:87], v[136:139], v[48:51]
    ds_read_b128 v[84:87], v3 offset:18432
    s_waitcnt lgkmcnt(5)
    v_mfma_f32_16x16x32_bf16 v[52:55], v[88:91], v[136:139], v[52:55]
    ds_read_b128 v[88:91], v3 offset:19456
    s_waitcnt lgkmcnt(5)
    v_mfma_f32_16x16x32_bf16 v[56:59], v[92:95], v[136:139], v[56:59]
    ds_read_b128 v[92:95], v3 offset:24576
    s_waitcnt lgkmcnt(5)
    v_mfma_f32_16x16x32_bf16 v[60:63], v[96:99], v[136:139], v[60:63]
    ds_read_b128 v[96:99], v3 offset:25600
    s_waitcnt lgkmcnt(5)
    s_waitcnt vmcnt(7)
    v_mfma_f32_16x16x32_bf16 v[48:51], v[76:79], v[140:143], v[48:51]
    ds_read_b128 v[76:79], v3 offset:26624
    s_waitcnt lgkmcnt(5)
    v_mfma_f32_16x16x32_bf16 v[52:55], v[80:83], v[140:143], v[52:55]
    ds_read_b128 v[80:83], v3 offset:27648
    s_waitcnt lgkmcnt(5)
    v_mfma_f32_16x16x32_bf16 v[56:59], v[84:87], v[140:143], v[56:59]
    ds_read_b128 v[84:87], v3 offset:57344
    s_waitcnt lgkmcnt(5)
    v_mfma_f32_16x16x32_bf16 v[60:63], v[88:91], v[140:143], v[60:63]
    ds_read_b128 v[88:91], v3 offset:58368
    s_waitcnt lgkmcnt(5)
    s_waitcnt vmcnt(6)
    v_mfma_f32_16x16x32_bf16 v[48:51], v[92:95], v[144:147], v[48:51]
    ds_read_b128 v[92:95], v3 offset:59392
    s_waitcnt lgkmcnt(5)
    v_mfma_f32_16x16x32_bf16 v[52:55], v[96:99], v[144:147], v[52:55]
    ds_read_b128 v[96:99], v3 offset:60416
    s_waitcnt lgkmcnt(5)
    v_mfma_f32_16x16x32_bf16 v[56:59], v[76:79], v[144:147], v[56:59]
    ds_read_b128 v[76:79], v46 offset:0
    s_waitcnt lgkmcnt(5)
    v_mfma_f32_16x16x32_bf16 v[60:63], v[80:83], v[144:147], v[60:63]
    ds_read_b128 v[80:83], v46 offset:1024
    s_waitcnt lgkmcnt(5)
    s_waitcnt vmcnt(5)
    v_mfma_f32_16x16x32_bf16 v[48:51], v[84:87], v[148:151], v[48:51]
    ds_read_b128 v[84:87], v46 offset:2048
    s_waitcnt lgkmcnt(5)
    v_mfma_f32_16x16x32_bf16 v[52:55], v[88:91], v[148:151], v[52:55]
    ds_read_b128 v[88:91], v46 offset:3072
    s_waitcnt lgkmcnt(5)
    v_mfma_f32_16x16x32_bf16 v[56:59], v[92:95], v[148:151], v[56:59]
    ds_read_b128 v[92:95], v46 offset:8192
    s_waitcnt lgkmcnt(5)
    v_mfma_f32_16x16x32_bf16 v[60:63], v[96:99], v[148:151], v[60:63]
    ds_read_b128 v[96:99], v46 offset:9216
    s_waitcnt lgkmcnt(5)
    s_waitcnt vmcnt(4)
    v_mfma_f32_16x16x32_bf16 v[48:51], v[76:79], v[152:155], v[48:51]
    ds_read_b128 v[76:79], v46 offset:10240
    s_waitcnt lgkmcnt(5)
    v_mfma_f32_16x16x32_bf16 v[52:55], v[80:83], v[152:155], v[52:55]
    ds_read_b128 v[80:83], v46 offset:11264
    s_waitcnt lgkmcnt(5)
    v_mfma_f32_16x16x32_bf16 v[56:59], v[84:87], v[152:155], v[56:59]
    ds_read_b128 v[84:87], v46 offset:16384
    s_waitcnt lgkmcnt(5)
    v_mfma_f32_16x16x32_bf16 v[60:63], v[88:91], v[152:155], v[60:63]
    ds_read_b128 v[88:91], v46 offset:17408
    s_waitcnt lgkmcnt(5)
    s_waitcnt vmcnt(3)
    v_mfma_f32_16x16x32_bf16 v[48:51], v[92:95], v[156:159], v[48:51]
    ds_read_b128 v[92:95], v46 offset:18432
    s_waitcnt lgkmcnt(5)
    v_mfma_f32_16x16x32_bf16 v[52:55], v[96:99], v[156:159], v[52:55]
    ds_read_b128 v[96:99], v46 offset:19456
    s_waitcnt lgkmcnt(5)
    v_mfma_f32_16x16x32_bf16 v[56:59], v[76:79], v[156:159], v[56:59]
    ds_read_b128 v[76:79], v46 offset:24576
    s_waitcnt lgkmcnt(5)
    v_mfma_f32_16x16x32_bf16 v[60:63], v[80:83], v[156:159], v[60:63]
    ds_read_b128 v[80:83], v46 offset:25600
    s_waitcnt lgkmcnt(5)
    s_waitcnt vmcnt(2)
    v_mfma_f32_16x16x32_bf16 v[48:51], v[84:87], v[160:163], v[48:51]
    ds_read_b128 v[84:87], v46 offset:26624
    s_waitcnt lgkmcnt(5)
    v_mfma_f32_16x16x32_bf16 v[52:55], v[88:91], v[160:163], v[52:55]
    ds_read_b128 v[88:91], v46 offset:27648
    s_waitcnt lgkmcnt(5)
    v_mfma_f32_16x16x32_bf16 v[56:59], v[92:95], v[160:163], v[56:59]
    ds_read_b128 v[92:95], v45 offset:4096
    s_waitcnt lgkmcnt(5)
    v_mfma_f32_16x16x32_bf16 v[60:63], v[96:99], v[160:163], v[60:63]
    ds_read_b128 v[96:99], v45 offset:5120
    s_waitcnt lgkmcnt(5)
    s_waitcnt vmcnt(1)
    v_mfma_f32_16x16x32_bf16 v[48:51], v[76:79], v[164:167], v[48:51]
    ds_read_b128 v[76:79], v45 offset:12288
    s_waitcnt lgkmcnt(5)
    v_mfma_f32_16x16x32_bf16 v[52:55], v[80:83], v[164:167], v[52:55]
    ds_read_b128 v[80:83], v45 offset:13312
    s_nop 3
    v_cvt_pk_bf16_f32 v32, 0, v48
    v_cvt_pk_bf16_f32 v33, 0, v49
    v_cvt_pk_bf16_f32 v34, 0, v50
    v_cvt_pk_bf16_f32 v35, 0, v51
    v_add_f32 v32, v32, v100
    s_waitcnt lgkmcnt(5)
    v_mfma_f32_16x16x32_bf16 v[56:59], v[84:87], v[164:167], v[56:59]
    ds_read_b128 v[84:87], v45 offset:20480
    v_add_f32 v33, v33, v101
    v_add_f32 v34, v34, v102
    v_add_f32 v35, v35, v103
    v_cvt_pk_bf16_f32 v32, 0, v32
    v_cvt_pk_bf16_f32 v33, 0, v33
    v_cvt_pk_bf16_f32 v34, 0, v34
    s_waitcnt lgkmcnt(5)
    v_mfma_f32_16x16x32_bf16 v[60:63], v[88:91], v[164:167], v[60:63]
    ds_read_b128 v[88:91], v45 offset:21504
    v_cvt_pk_bf16_f32 v35, 0, v35
    v_mul_f32 v36, v32, v32
    v_mul_f32 v37, v33, v33
    v_mul_f32 v38, v34, v34
    v_mul_f32 v39, v35, v35
    v_fmaak_f32 v36, v42, v36, 0xc0135761
    s_cmp_eq_u32 s60, 1
    s_cbranch_scc1 fused_kernel_cb19
    s_barrier
fused_kernel_cb19:
    s_cmp_lg_u32 s60, 0
    s_cbranch_scc1 fused_kernel_ed20
    s_add_u32 s52, s68, 0x0
    s_add_u32 m0, s65, 0x0
    s_nop 0
    buffer_load_dwordx4 v4, s[24:27], s52 offen lds
    s_add_u32 s52, s68, 0x2000
    s_add_u32 m0, s65, 0x400
    s_nop 0
    buffer_load_dwordx4 v4, s[24:27], s52 offen lds
    s_add_u32 s52, s68, 0x4000
    s_add_u32 m0, s65, 0x800
    s_nop 0
    buffer_load_dwordx4 v4, s[24:27], s52 offen lds
    s_add_u32 s52, s68, 0x6000
    s_add_u32 m0, s65, 0xc00
    s_nop 0
    buffer_load_dwordx4 v4, s[24:27], s52 offen lds
    s_add_u32 s52, s68, 0x8000
    s_add_u32 m0, s65, 0x1000
    s_nop 0
    buffer_load_dwordx4 v4, s[24:27], s52 offen lds
    s_add_u32 s52, s68, 0xa000
    s_add_u32 m0, s65, 0x1400
    s_nop 0
    buffer_load_dwordx4 v4, s[24:27], s52 offen lds
    s_add_u32 s52, s68, 0xc000
    s_add_u32 m0, s65, 0x1800
    s_nop 0
    buffer_load_dwordx4 v4, s[24:27], s52 offen lds
    s_add_u32 s52, s68, 0xe000
    s_add_u32 m0, s65, 0x1c00
    s_nop 0
    buffer_load_dwordx4 v4, s[24:27], s52 offen lds
fused_kernel_ed20:
    s_waitcnt lgkmcnt(5)
    v_mfma_f32_16x16x32_bf16 v[64:67], v[92:95], v[104:107], 0
    ds_read_b128 v[92:95], v45 offset:28672
    v_fmaak_f32 v37, v42, v37, 0xc0135761
    v_fmaak_f32 v38, v42, v38, 0xc0135761
    v_fmaak_f32 v39, v42, v39, 0xc0135761
    v_mul_f32 v36, v32, v36
    v_mul_f32 v37, v33, v37
    v_mul_f32 v38, v34, v38
    s_waitcnt lgkmcnt(5)
    v_mfma_f32_16x16x32_bf16 v[68:71], v[96:99], v[104:107], 0
    ds_read_b128 v[96:99], v45 offset:29696
    v_mul_f32 v39, v35, v39
    v_exp_f32 v36, v36
    v_exp_f32 v37, v37
    v_exp_f32 v38, v38
    v_exp_f32 v39, v39
    v_add_f32 v36, 1.0, v36
    s_waitcnt lgkmcnt(5)
    v_mfma_f32_16x16x32_bf16 v[64:67], v[76:79], v[108:111], v[64:67]
    ds_read_b128 v[76:79], v3 offset:36864
    v_add_f32 v37, 1.0, v37
    v_add_f32 v38, 1.0, v38
    v_add_f32 v39, 1.0, v39
    v_rcp_f32 v36, v36
    v_rcp_f32 v37, v37
    v_rcp_f32 v38, v38
    s_waitcnt lgkmcnt(5)
    v_mfma_f32_16x16x32_bf16 v[68:71], v[80:83], v[108:111], v[68:71]
    ds_read_b128 v[80:83], v3 offset:37888
    v_rcp_f32 v39, v39
    v_mul_f32 v32, v32, v36
    v_mul_f32 v33, v33, v37
    v_mul_f32 v34, v34, v38
    v_mul_f32 v35, v35, v39
    v_cvt_pk_bf16_f32 v48, v32, v33
    s_waitcnt lgkmcnt(5)
    v_mfma_f32_16x16x32_bf16 v[64:67], v[84:87], v[112:115], v[64:67]
    ds_read_b128 v[84:87], v3 offset:45056
    v_cvt_pk_bf16_f32 v49, v34, v35
    ds_read_b128 v[100:103], v43 offset:128
    v_cvt_pk_bf16_f32 v32, 0, v52
    v_cvt_pk_bf16_f32 v33, 0, v53
    v_cvt_pk_bf16_f32 v34, 0, v54
    v_cvt_pk_bf16_f32 v35, 0, v55
    s_waitcnt lgkmcnt(6)
    v_mfma_f32_16x16x32_bf16 v[68:71], v[88:91], v[112:115], v[68:71]
    ds_read_b128 v[88:91], v3 offset:46080
    v_add_f32 v32, v32, v12
    v_add_f32 v33, v33, v13
    v_add_f32 v34, v34, v14
    v_add_f32 v35, v35, v15
    v_cvt_pk_bf16_f32 v32, 0, v32
    v_cvt_pk_bf16_f32 v33, 0, v33
    s_waitcnt lgkmcnt(6)
    v_mfma_f32_16x16x32_bf16 v[64:67], v[92:95], v[116:119], v[64:67]
    ds_read_b128 v[92:95], v3 offset:53248
    v_cvt_pk_bf16_f32 v34, 0, v34
    v_cvt_pk_bf16_f32 v35, 0, v35
    v_mul_f32 v36, v32, v32
    v_mul_f32 v37, v33, v33
    v_mul_f32 v38, v34, v34
    v_mul_f32 v39, v35, v35
    s_waitcnt lgkmcnt(6)
    v_mfma_f32_16x16x32_bf16 v[68:71], v[96:99], v[116:119], v[68:71]
    ds_read_b128 v[96:99], v3 offset:54272
    v_fmaak_f32 v36, v42, v36, 0xc0135761
    v_fmaak_f32 v37, v42, v37, 0xc0135761
    v_fmaak_f32 v38, v42, v38, 0xc0135761
    v_fmaak_f32 v39, v42, v39, 0xc0135761
    v_mul_f32 v36, v32, v36
    v_mul_f32 v37, v33, v37
    s_waitcnt lgkmcnt(6)
    v_mfma_f32_16x16x32_bf16 v[64:67], v[76:79], v[120:123], v[64:67]
    ds_read_b128 v[76:79], v3 offset:4096
    v_mul_f32 v38, v34, v38
    v_mul_f32 v39, v35, v39
    v_exp_f32 v36, v36
    v_exp_f32 v37, v37
    v_exp_f32 v38, v38
    v_exp_f32 v39, v39
    s_waitcnt lgkmcnt(6)
    v_mfma_f32_16x16x32_bf16 v[68:71], v[80:83], v[120:123], v[68:71]
    ds_read_b128 v[80:83], v3 offset:5120
    v_add_f32 v36, 1.0, v36
    v_add_f32 v37, 1.0, v37
    v_add_f32 v38, 1.0, v38
    v_add_f32 v39, 1.0, v39
    v_rcp_f32 v36, v36
    v_rcp_f32 v37, v37
    s_waitcnt lgkmcnt(6)
    v_mfma_f32_16x16x32_bf16 v[64:67], v[84:87], v[124:127], v[64:67]
    ds_read_b128 v[84:87], v3 offset:12288
    v_rcp_f32 v38, v38
    v_rcp_f32 v39, v39
    v_mul_f32 v32, v32, v36
    v_mul_f32 v33, v33, v37
    v_mul_f32 v34, v34, v38
    v_mul_f32 v35, v35, v39
    s_waitcnt lgkmcnt(5)
    v_mfma_f32_16x16x32_bf16 v[68:71], v[88:91], v[124:127], v[68:71]
    ds_read_b128 v[88:91], v3 offset:13312
    v_cvt_pk_bf16_f32 v50, v32, v33
    v_cvt_pk_bf16_f32 v51, v34, v35
    ds_read_b128 v[12:15], v43 offset:192
    s_bitcmp1_b32 s56, 0
    s_cbranch_scc1 fused_kernel_pw21
    buffer_store_dwordx4 v[48:51], v3, s[40:43], s53 offen offset:0 sc1
fused_kernel_pw21:
    s_nop 1
    v_cvt_pk_bf16_f32 v32, 0, v56
    v_cvt_pk_bf16_f32 v33, 0, v57
    v_cvt_pk_bf16_f32 v34, 0, v58
    v_cvt_pk_bf16_f32 v35, 0, v59
    s_waitcnt lgkmcnt(6)
    v_mfma_f32_16x16x32_bf16 v[64:67], v[92:95], v[128:131], v[64:67]
    ds_read_b128 v[92:95], v3 offset:20480
    v_add_f32 v32, v32, v100
    v_add_f32 v33, v33, v101
    v_add_f32 v34, v34, v102
    v_add_f32 v35, v35, v103
    v_cvt_pk_bf16_f32 v32, 0, v32
    s_waitcnt lgkmcnt(6)
    v_mfma_f32_16x16x32_bf16 v[68:71], v[96:99], v[128:131], v[68:71]
    ds_read_b128 v[96:99], v3 offset:21504
    v_cvt_pk_bf16_f32 v33, 0, v33
    v_cvt_pk_bf16_f32 v34, 0, v34
    v_cvt_pk_bf16_f32 v35, 0, v35
    v_mul_f32 v36, v32, v32
    v_mul_f32 v37, v33, v33
    v_mul_f32 v38, v34, v34
    s_waitcnt lgkmcnt(6)
    v_mfma_f32_16x16x32_bf16 v[64:67], v[76:79], v[132:135], v[64:67]
    ds_read_b128 v[76:79], v3 offset:28672
    v_mul_f32 v39, v35, v35
    v_fmaak_f32 v36, v42, v36, 0xc0135761
    v_fmaak_f32 v37, v42, v37, 0xc0135761
    v_fmaak_f32 v38, v42, v38, 0xc0135761
    v_fmaak_f32 v39, v42, v39, 0xc0135761
    v_mul_f32 v36, v32, v36
    s_waitcnt lgkmcnt(6)
    v_mfma_f32_16x16x32_bf16 v[68:71], v[80:83], v[132:135], v[68:71]
    ds_read_b128 v[80:83], v3 offset:29696
    v_mul_f32 v37, v33, v37
    v_mul_f32 v38, v34, v38
    v_mul_f32 v39, v35, v39
    v_exp_f32 v36, v36
    v_exp_f32 v37, v37
    v_exp_f32 v38, v38
    s_waitcnt lgkmcnt(6)
    v_mfma_f32_16x16x32_bf16 v[64:67], v[84:87], v[136:139], v[64:67]
    ds_read_b128 v[84:87], v3 offset:61440
    v_exp_f32 v39, v39
    v_add_f32 v36, 1.0, v36
    v_add_f32 v37, 1.0, v37
    v_add_f32 v38, 1.0, v38
    v_add_f32 v39, 1.0, v39
    v_rcp_f32 v36, v36
    s_waitcnt lgkmcnt(6)
    v_mfma_f32_16x16x32_bf16 v[68:71], v[88:91], v[136:139], v[68:71]
    ds_read_b128 v[88:91], v3 offset:62464
    v_rcp_f32 v37, v37
    v_rcp_f32 v38, v38
    v_rcp_f32 v39, v39
    v_mul_f32 v32, v32, v36
    v_mul_f32 v33, v33, v37
    v_mul_f32 v34, v34, v38
    s_waitcnt lgkmcnt(5)
    v_mfma_f32_16x16x32_bf16 v[64:67], v[92:95], v[140:143], v[64:67]
    ds_read_b128 v[92:95], v46 offset:4096
    v_mul_f32 v35, v35, v39
    v_cvt_pk_bf16_f32 v52, v32, v33
    v_cvt_pk_bf16_f32 v53, v34, v35
    ds_read_b128 v[100:103], v43 offset:256
    s_bitcmp1_b32 s56, 0
    s_cbranch_scc0 fused_kernel_pw22
    buffer_store_dwordx4 v[50:53], v3, s[40:43], s53 offen offset:1024 sc1
fused_kernel_pw22:
    s_nop 1
    v_cvt_pk_bf16_f32 v32, 0, v60
    v_cvt_pk_bf16_f32 v33, 0, v61
    v_cvt_pk_bf16_f32 v34, 0, v62
    s_waitcnt lgkmcnt(6)
    v_mfma_f32_16x16x32_bf16 v[68:71], v[96:99], v[140:143], v[68:71]
    ds_read_b128 v[96:99], v46 offset:5120
    v_cvt_pk_bf16_f32 v35, 0, v63
    v_add_f32 v32, v32, v12
    v_add_f32 v33, v33, v13
    v_add_f32 v34, v34, v14
    v_add_f32 v35, v35, v15
    s_waitcnt lgkmcnt(6)
    v_mfma_f32_16x16x32_bf16 v[64:67], v[76:79], v[144:147], v[64:67]
    ds_read_b128 v[76:79], v46 offset:12288
    v_cvt_pk_bf16_f32 v32, 0, v32
    v_cvt_pk_bf16_f32 v33, 0, v33
    v_cvt_pk_bf16_f32 v34, 0, v34
    v_cvt_pk_bf16_f32 v35, 0, v35
    v_mul_f32 v36, v32, v32
    v_mul_f32 v37, v33, v33
    s_waitcnt lgkmcnt(6)
    v_mfma_f32_16x16x32_bf16 v[68:71], v[80:83], v[144:147], v[68:71]
    ds_read_b128 v[80:83], v46 offset:13312
    v_mul_f32 v38, v34, v34
    v_mul_f32 v39, v35, v35
    v_fmaak_f32 v36, v42, v36, 0xc0135761
    v_fmaak_f32 v37, v42, v37, 0xc0135761
    v_fmaak_f32 v38, v42, v38, 0xc0135761
    v_fmaak_f32 v39, v42, v39, 0xc0135761
    s_waitcnt lgkmcnt(6)
    v_mfma_f32_16x16x32_bf16 v[64:67], v[84:87], v[148:151], v[64:67]
    ds_read_b128 v[84:87], v46 offset:20480
    v_mul_f32 v36, v32, v36
    v_mul_f32 v37, v33, v37
    v_mul_f32 v38, v34, v38
    v_mul_f32 v39, v35, v39
    v_exp_f32 v36, v36
    v_exp_f32 v37, v37
    s_waitcnt lgkmcnt(6)
    v_mfma_f32_16x16x32_bf16 v[68:71], v[88:91], v[148:151], v[68:71]
    ds_read_b128 v[88:91], v46 offset:21504
    v_exp_f32 v38, v38
    v_exp_f32 v39, v39
    v_add_f32 v36, 1.0, v36
    v_add_f32 v37, 1.0, v37
    v_add_f32 v38, 1.0, v38
    v_add_f32 v39, 1.0, v39
    s_waitcnt lgkmcnt(6)
    v_mfma_f32_16x16x32_bf16 v[64:67], v[92:95], v[152:155], v[64:67]
    ds_read_b128 v[92:95], v46 offset:28672
    v_rcp_f32 v36, v36
    v_rcp_f32 v37, v37
    v_rcp_f32 v38, v38
    v_rcp_f32 v39, v39
    v_mul_f32 v32, v32, v36
    v_mul_f32 v33, v33, v37
    s_waitcnt lgkmcnt(5)
    v_mfma_f32_16x16x32_bf16 v[68:71], v[96:99], v[152:155], v[68:71]
    ds_read_b128 v[96:99], v46 offset:29696
    v_mul_f32 v34, v34, v38
    v_mul_f32 v35, v35, v39
    v_cvt_pk_bf16_f32 v54, v32, v33
    v_cvt_pk_bf16_f32 v55, v34, v35
    ds_read_b128 v[12:15], v43 offset:320
    s_bitcmp1_b32 s56, 0
    s_cbranch_scc1 fused_kernel_pw23
    buffer_store_dwordx4 v[52:55], v3, s[40:43], s53 offen offset:1024 sc1
fused_kernel_pw23:
    s_nop 1
    s_waitcnt lgkmcnt(6)
    v_mfma_f32_16x16x32_bf16 v[64:67], v[76:79], v[156:159], v[64:67]
    ds_read_b128 v[76:79], v45 offset:6144
    s_waitcnt lgkmcnt(6)
    v_mfma_f32_16x16x32_bf16 v[68:71], v[80:83], v[156:159], v[68:71]
    ds_read_b128 v[80:83], v45 offset:14336
    s_waitcnt lgkmcnt(6)
    v_mfma_f32_16x16x32_bf16 v[64:67], v[84:87], v[160:163], v[64:67]
    ds_read_b128 v[84:87], v45 offset:22528
    s_waitcnt lgkmcnt(6)
    v_mfma_f32_16x16x32_bf16 v[68:71], v[88:91], v[160:163], v[68:71]
    ds_read_b128 v[88:91], v45 offset:30720
    s_waitcnt lgkmcnt(6)
    v_mfma_f32_16x16x32_bf16 v[64:67], v[92:95], v[164:167], v[64:67]
    ds_read_b128 v[92:95], v3 offset:38912
    s_waitcnt lgkmcnt(6)
    v_mfma_f32_16x16x32_bf16 v[68:71], v[96:99], v[164:167], v[68:71]
    ds_read_b128 v[96:99], v3 offset:47104
    s_nop 3
    v_cvt_pk_bf16_f32 v32, 0, v64
    v_cvt_pk_bf16_f32 v33, 0, v65
    v_cvt_pk_bf16_f32 v34, 0, v66
    v_cvt_pk_bf16_f32 v35, 0, v67
    v_add_f32 v32, v32, v100
    s_waitcnt lgkmcnt(5)
    v_mfma_f32_16x16x32_bf16 v[72:75], v[76:79], v[104:107], 0
    ds_read_b128 v[76:79], v3 offset:55296
    v_add_f32 v33, v33, v101
    v_add_f32 v34, v34, v102
    v_add_f32 v35, v35, v103
    v_cvt_pk_bf16_f32 v32, 0, v32
    v_cvt_pk_bf16_f32 v33, 0, v33
    v_cvt_pk_bf16_f32 v34, 0, v34
    s_waitcnt lgkmcnt(5)
    v_mfma_f32_16x16x32_bf16 v[72:75], v[80:83], v[108:111], v[72:75]
    ds_read_b128 v[80:83], v3 offset:6144
    v_cvt_pk_bf16_f32 v35, 0, v35
    v_mul_f32 v36, v32, v32
    v_mul_f32 v37, v33, v33
    v_mul_f32 v38, v34, v34
    v_mul_f32 v39, v35, v35
    v_fmaak_f32 v36, v42, v36, 0xc0135761
    s_waitcnt lgkmcnt(5)
    v_mfma_f32_16x16x32_bf16 v[72:75], v[84:87], v[112:115], v[72:75]
    ds_read_b128 v[84:87], v3 offset:14336
    v_fmaak_f32 v37, v42, v37, 0xc0135761
    v_fmaak_f32 v38, v42, v38, 0xc0135761
    v_fmaak_f32 v39, v42, v39, 0xc0135761
    v_mul_f32 v36, v32, v36
    v_mul_f32 v37, v33, v37
    v_mul_f32 v38, v34, v38
    s_waitcnt lgkmcnt(5)
    v_mfma_f32_16x16x32_bf16 v[72:75], v[88:91], v[116:119], v[72:75]
    ds_read_b128 v[88:91], v3 offset:22528
    v_mul_f32 v39, v35, v39
    v_exp_f32 v36, v36
    v_exp_f32 v37, v37
    v_exp_f32 v38, v38
    v_exp_f32 v39, v39
    v_add_f32 v36, 1.0, v36
    s_waitcnt lgkmcnt(5)
    v_mfma_f32_16x16x32_bf16 v[72:75], v[92:95], v[120:123], v[72:75]
    ds_read_b128 v[92:95], v3 offset:30720
    v_add_f32 v37, 1.0, v37
    v_add_f32 v38, 1.0, v38
    v_add_f32 v39, 1.0, v39
    v_rcp_f32 v36, v36
    v_rcp_f32 v37, v37
    v_rcp_f32 v38, v38
    s_waitcnt lgkmcnt(5)
    v_mfma_f32_16x16x32_bf16 v[72:75], v[96:99], v[124:127], v[72:75]
    ds_read_b128 v[96:99], v3 offset:63488
    v_rcp_f32 v39, v39
    v_mul_f32 v32, v32, v36
    v_mul_f32 v33, v33, v37
    v_mul_f32 v34, v34, v38
    v_mul_f32 v35, v35, v39
    v_cvt_pk_bf16_f32 v56, v32, v33
    s_waitcnt lgkmcnt(5)
    v_mfma_f32_16x16x32_bf16 v[72:75], v[76:79], v[128:131], v[72:75]
    ds_read_b128 v[76:79], v46 offset:6144
    v_cvt_pk_bf16_f32 v57, v34, v35
    ds_read_b128 v[100:103], v43 offset:384
    s_bitcmp1_b32 s56, 0
    s_cbranch_scc0 fused_kernel_pw24
    buffer_store_dwordx4 v[54:57], v3, s[40:43], s53 offen offset:2048 sc1
fused_kernel_pw24:
    s_nop 1
    v_cvt_pk_bf16_f32 v32, 0, v68
    v_cvt_pk_bf16_f32 v33, 0, v69
    v_cvt_pk_bf16_f32 v34, 0, v70
    v_cvt_pk_bf16_f32 v35, 0, v71
    s_waitcnt lgkmcnt(6)
    v_mfma_f32_16x16x32_bf16 v[72:75], v[80:83], v[132:135], v[72:75]
    ds_read_b128 v[80:83], v46 offset:14336
    v_add_f32 v32, v32, v12
    v_add_f32 v33, v33, v13
    v_add_f32 v34, v34, v14
    v_add_f32 v35, v35, v15
    v_cvt_pk_bf16_f32 v32, 0, v32
    v_cvt_pk_bf16_f32 v33, 0, v33
    s_waitcnt lgkmcnt(6)
    v_mfma_f32_16x16x32_bf16 v[72:75], v[84:87], v[136:139], v[72:75]
    ds_read_b128 v[84:87], v46 offset:22528
    v_cvt_pk_bf16_f32 v34, 0, v34
    v_cvt_pk_bf16_f32 v35, 0, v35
    v_mul_f32 v36, v32, v32
    v_mul_f32 v37, v33, v33
    v_mul_f32 v38, v34, v34
    v_mul_f32 v39, v35, v35
    s_waitcnt lgkmcnt(6)
    v_mfma_f32_16x16x32_bf16 v[72:75], v[88:91], v[140:143], v[72:75]
    ds_read_b128 v[88:91], v46 offset:30720
    v_fmaak_f32 v36, v42, v36, 0xc0135761
    v_fmaak_f32 v37, v42, v37, 0xc0135761
    v_fmaak_f32 v38, v42, v38, 0xc0135761
    v_fmaak_f32 v39, v42, v39, 0xc0135761
    v_mul_f32 v36, v32, v36
    v_mul_f32 v37, v33, v37
    s_waitcnt lgkmcnt(6)
    v_mfma_f32_16x16x32_bf16 v[72:75], v[92:95], v[144:147], v[72:75]
    v_mul_f32 v38, v34, v38
    v_mul_f32 v39, v35, v39
    v_exp_f32 v36, v36
    v_exp_f32 v37, v37
    v_exp_f32 v38, v38
    v_exp_f32 v39, v39
    s_waitcnt lgkmcnt(5)
    v_mfma_f32_16x16x32_bf16 v[72:75], v[96:99], v[148:151], v[72:75]
    v_add_f32 v36, 1.0, v36
    v_add_f32 v37, 1.0, v37
    v_add_f32 v38, 1.0, v38
    v_add_f32 v39, 1.0, v39
    v_rcp_f32 v36, v36
    v_rcp_f32 v37, v37
    s_waitcnt lgkmcnt(4)
    v_mfma_f32_16x16x32_bf16 v[72:75], v[76:79], v[152:155], v[72:75]
    v_rcp_f32 v38, v38
    v_rcp_f32 v39, v39
    v_mul_f32 v32, v32, v36
    v_mul_f32 v33, v33, v37
    v_mul_f32 v34, v34, v38
    v_mul_f32 v35, v35, v39
    s_waitcnt lgkmcnt(2)
    v_mfma_f32_16x16x32_bf16 v[72:75], v[80:83], v[156:159], v[72:75]
    v_cvt_pk_bf16_f32 v58, v32, v33
    v_cvt_pk_bf16_f32 v59, v34, v35
    s_bitcmp1_b32 s56, 0
    s_cbranch_scc1 fused_kernel_pw25
    buffer_store_dwordx4 v[56:59], v3, s[40:43], s53 offen offset:2048 sc1
fused_kernel_pw25:
    s_nop 1
    s_waitcnt lgkmcnt(1)
    v_mfma_f32_16x16x32_bf16 v[72:75], v[84:87], v[160:163], v[72:75]
    s_waitcnt lgkmcnt(0)
    v_mfma_f32_16x16x32_bf16 v[72:75], v[88:91], v[164:167], v[72:75]
    s_waitcnt lgkmcnt(0)
    s_cmp_eq_u32 s60, 0
    s_cbranch_scc1 fused_kernel_cb26
    s_barrier
fused_kernel_cb26:
    s_nop 3
    v_cvt_pk_bf16_f32 v32, 0, v72
    v_cvt_pk_bf16_f32 v33, 0, v73
    v_cvt_pk_bf16_f32 v34, 0, v74
    v_cvt_pk_bf16_f32 v35, 0, v75
    v_add_f32 v32, v32, v100
    v_add_f32 v33, v33, v101
    v_add_f32 v34, v34, v102
    v_add_f32 v35, v35, v103
    v_cvt_pk_bf16_f32 v32, 0, v32
    v_cvt_pk_bf16_f32 v33, 0, v33
    v_cvt_pk_bf16_f32 v34, 0, v34
    v_cvt_pk_bf16_f32 v35, 0, v35
    v_mul_f32 v36, v32, v32
    v_mul_f32 v37, v33, v33
    v_mul_f32 v38, v34, v34
    v_mul_f32 v39, v35, v35
    v_fmaak_f32 v36, v42, v36, 0xc0135761
    v_fmaak_f32 v37, v42, v37, 0xc0135761
    v_fmaak_f32 v38, v42, v38, 0xc0135761
    v_fmaak_f32 v39, v42, v39, 0xc0135761
    v_mul_f32 v36, v32, v36
    v_mul_f32 v37, v33, v37
    v_mul_f32 v38, v34, v38
    v_mul_f32 v39, v35, v39
    v_exp_f32 v36, v36
    v_exp_f32 v37, v37
    v_exp_f32 v38, v38
    v_exp_f32 v39, v39
    v_add_f32 v36, 1.0, v36
    v_add_f32 v37, 1.0, v37
    v_add_f32 v38, 1.0, v38
    v_add_f32 v39, 1.0, v39
    v_rcp_f32 v36, v36
    v_rcp_f32 v37, v37
    v_rcp_f32 v38, v38
    v_rcp_f32 v39, v39
    v_mul_f32 v32, v32, v36
    v_mul_f32 v33, v33, v37
    v_mul_f32 v34, v34, v38
    v_mul_f32 v35, v35, v39
    v_cvt_pk_bf16_f32 v60, v32, v33
    v_cvt_pk_bf16_f32 v61, v34, v35
    s_mul_i32 s50, s57, 57344
    s_add_u32 s50, s50, s73
    s_mul_i32 s51, s56, 7
    s_lshr_b32 s51, s51, 1
    s_lshl_b32 s51, s51, 10
    s_add_u32 s50, s50, s51
    s_bitcmp1_b32 s56, 0
    s_cbranch_scc1 fused_kernel_odd27
    buffer_store_dwordx2 v[60:61], v3, s[40:43], s50 offen offset:3072
    s_branch fused_kernel_gs28
fused_kernel_odd27:
    buffer_store_dwordx2 v[48:49], v3, s[40:43], s50 offen offset:8
    buffer_store_dwordx4 v[58:61], v3, s[40:43], s50 offen offset:3072
fused_kernel_gs28:
    v_bfe_u32 v5, v1, 2, 2
    v_lshl_add_u32 v6, v2, 2, v5
    v_bfe_u32 v7, v6, 1, 2
    v_lshlrev_b32 v5, 7, v6
    v_and_b32 v6, 3, v1
    v_lshl_add_u32 v5, v6, 3, v5
    v_xor_b32 v6, 0, v7
    v_lshl_add_u32 v24, v6, 5, v5
    v_xor_b32 v6, 1, v7
    v_lshl_add_u32 v25, v6, 5, v5
    v_xor_b32 v6, 2, v7
    v_lshl_add_u32 v26, v6, 5, v5
    v_xor_b32 v6, 3, v7
    v_lshl_add_u32 v27, v6, 5, v5
    s_lshl_b32 s51, s60, 12
    v_add_u32 v12, s65, v24
    v_add_u32 v5, s64, v24
    v_add_u32 v13, s65, v25
    v_add_u32 v6, s64, v25
    v_add_u32 v14, s65, v26
    v_add_u32 v7, s64, v26
    v_add_u32 v15, s65, v27
    v_add_u32 v8, s64, v27
    v_lshrrev_b32 v28, 1, v2
    v_lshl_add_u32 v28, v28, 1, v1
    v_and_b32 v28, 15, v28
    v_lshlrev_b32 v28, 4, v28
    v_lshl_add_u32 v28, v2, 8, v28
    v_add_u32 v10, s64, v28
    v_and_b32 v28, 7, v1
    v_lshrrev_b32 v29, 3, v1
    s_and_b32 s51, s44, 1
    s_lshl_b32 s51, s51, 3
    v_add_u32 v29, s51, v29
    v_lshl_add_u32 v29, v28, 1, v29
    v_and_b32 v29, 15, v29
    v_lshlrev_b32 v29, 4, v29
    v_lshl_add_u32 v29, v28, 9, v29
    s_lshr_b32 s51, s44, 1
    s_lshl_b32 s51, s51, 12
    s_add_u32 s51, s51, 16384
    v_add_u32 v11, s51, v29
    s_movk_i32 s69, 0xff
    v_add_u32 v1, 0x10000, v11
    v_add_u32 v2, 0x20000, v11
    s_sub_u32 s50, s58, s61
    s_mul_i32 s62, s50, 57344
    s_add_u32 s62, s62, s73
    s_lshl_b32 s50, s61, 11
    s_add_u32 s62, s62, s50
    s_add_u32 s63, s62, 0xe000
    s_add_u32 s66, s62, 0x1c000
    s_add_u32 s67, s62, 0x2a000
    s_cmp_lg_u32 s60, 0
    s_cbranch_scc1 fused_kernel_pre29
    s_waitcnt vmcnt(4)
    ds_read_b64_tr_b16 v[28:29], v12 offset:0
    ds_read_b64_tr_b16 v[30:31], v12 offset:2048
    ds_read_b64_tr_b16 v[32:33], v13 offset:0
    ds_read_b64_tr_b16 v[34:35], v13 offset:2048
    ds_read_b64_tr_b16 v[36:37], v14 offset:0
    ds_read_b64_tr_b16 v[38:39], v14 offset:2048
    ds_read_b64_tr_b16 v[164:165], v15 offset:0
    ds_read_b64_tr_b16 v[166:167], v15 offset:2048
    ds_read_b64_tr_b16 v[88:89], v12 offset:4096
    ds_read_b64_tr_b16 v[90:91], v12 offset:6144
    ds_read_b64_tr_b16 v[92:93], v13 offset:4096
    ds_read_b64_tr_b16 v[94:95], v13 offset:6144
    ds_read_b64_tr_b16 v[96:97], v14 offset:4096
    ds_read_b64_tr_b16 v[98:99], v14 offset:6144
    ds_read_b64_tr_b16 v[100:101], v15 offset:4096
    ds_read_b64_tr_b16 v[102:103], v15 offset:6144
    s_waitcnt lgkmcnt(0)
    s_add_u32 s52, s68, 0x40000
    s_add_u32 m0, s65, 0x0
    s_nop 0
    buffer_load_dwordx4 v4, s[24:27], s52 offen lds
    s_add_u32 s52, s68, 0x42000
    s_add_u32 m0, s65, 0x400
    s_nop 0
    buffer_load_dwordx4 v4, s[24:27], s52 offen lds
    s_add_u32 s52, s68, 0x44000
    s_add_u32 m0, s65, 0x800
    s_nop 0
    buffer_load_dwordx4 v4, s[24:27], s52 offen lds
    s_add_u32 s52, s68, 0x46000
    s_add_u32 m0, s65, 0xc00
    s_nop 0
    buffer_load_dwordx4 v4, s[24:27], s52 offen lds
    s_add_u32 s52, s68, 0x48000
    s_add_u32 m0, s65, 0x1000
    s_nop 0
    buffer_load_dwordx4 v4, s[24:27], s52 offen lds
    s_add_u32 s52, s68, 0x4a000
    s_add_u32 m0, s65, 0x1400
    s_nop 0
    buffer_load_dwordx4 v4, s[24:27], s52 offen lds
    s_add_u32 s52, s68, 0x4c000
    s_add_u32 m0, s65, 0x1800
    s_nop 0
    buffer_load_dwordx4 v4, s[24:27], s52 offen lds
    s_add_u32 s52, s68, 0x4e000
    s_add_u32 m0, s65, 0x1c00
    s_nop 0
    buffer_load_dwordx4 v4, s[24:27], s52 offen lds
fused_kernel_pre29:
    s_cmp_eq_u32 s60, 1
    s_cbranch_scc1 fused_kernel_cb30
    s_barrier
fused_kernel_cb30:
    s_waitcnt vmcnt(0)
    s_barrier
    s_barrier
    s_cmp_lg_u32 s60, 0
    s_cbranch_scc1 fused_kernel_j431
    buffer_load_dwordx4 v[104:107], v3, s[40:43], s62 offen sc1
    buffer_load_dwordx4 v[108:111], v3, s[40:43], s63 offen sc1
    buffer_load_dwordx4 v[112:115], v3, s[40:43], s66 offen sc1
    buffer_load_dwordx4 v[116:119], v3, s[40:43], s67 offen sc1
    buffer_load_dwordx4 v[120:123], v3, s[40:43], s62 offen offset:1024 sc1
    buffer_load_dwordx4 v[124:127], v3, s[40:43], s63 offen offset:1024 sc1
    buffer_load_dwordx4 v[128:131], v3, s[40:43], s66 offen offset:1024 sc1
    buffer_load_dwordx4 v[132:135], v3, s[40:43], s67 offen offset:1024 sc1
    s_add_u32 s62, s62, 24576
    buffer_load_dwordx4 v[136:139], v3, s[40:43], s62 offen sc1
    s_add_u32 s63, s63, 24576
    buffer_load_dwordx4 v[140:143], v3, s[40:43], s63 offen sc1
    s_add_u32 s66, s66, 24576
    buffer_load_dwordx4 v[144:147], v3, s[40:43], s66 offen sc1
    s_add_u32 s67, s67, 24576
    buffer_load_dwordx4 v[148:151], v3, s[40:43], s67 offen sc1
    buffer_load_dwordx4 v[152:155], v3, s[40:43], s62 offen offset:1024 sc1
    buffer_load_dwordx4 v[156:159], v3, s[40:43], s63 offen offset:1024 sc1
    buffer_load_dwordx4 v[160:163], v3, s[40:43], s66 offen offset:1024 sc1
    s_waitcnt vmcnt(14)
    v_mfma_f32_16x16x32_bf16 v[24:27], v[28:31], v[104:107], 0
    s_waitcnt vmcnt(13)
    v_mfma_f32_16x16x32_bf16 v[40:43], v[28:31], v[108:111], 0
    s_waitcnt vmcnt(12)
    v_mfma_f32_16x16x32_bf16 v[56:59], v[28:31], v[112:115], 0
    s_waitcnt vmcnt(11)
    v_mfma_f32_16x16x32_bf16 v[72:75], v[28:31], v[116:119], 0
    v_mfma_f32_16x16x32_bf16 v[28:31], v[32:35], v[104:107], 0
    v_mfma_f32_16x16x32_bf16 v[44:47], v[32:35], v[108:111], 0
    v_mfma_f32_16x16x32_bf16 v[60:63], v[32:35], v[112:115], 0
    v_mfma_f32_16x16x32_bf16 v[76:79], v[32:35], v[116:119], 0
    v_mfma_f32_16x16x32_bf16 v[32:35], v[36:39], v[104:107], 0
    v_mfma_f32_16x16x32_bf16 v[48:51], v[36:39], v[108:111], 0
    v_mfma_f32_16x16x32_bf16 v[64:67], v[36:39], v[112:115], 0
    v_mfma_f32_16x16x32_bf16 v[80:83], v[36:39], v[116:119], 0
    v_mfma_f32_16x16x32_bf16 v[36:39], v[164:167], v[104:107], 0
    v_mfma_f32_16x16x32_bf16 v[52:55], v[164:167], v[108:111], 0
    v_mfma_f32_16x16x32_bf16 v[68:71], v[164:167], v[112:115], 0
    v_mfma_f32_16x16x32_bf16 v[84:87], v[164:167], v[116:119], 0
    buffer_load_dwordx4 v[164:167], v3, s[40:43], s67 offen offset:1024 sc1
    s_add_u32 s62, s62, 8192
    buffer_load_dwordx4 v[104:107], v3, s[40:43], s62 offen sc1
    s_add_u32 s63, s63, 8192
    buffer_load_dwordx4 v[108:111], v3, s[40:43], s63 offen sc1
    s_add_u32 s66, s66, 8192
    buffer_load_dwordx4 v[112:115], v3, s[40:43], s66 offen sc1
    s_add_u32 s67, s67, 8192
    buffer_load_dwordx4 v[116:119], v3, s[40:43], s67 offen sc1
    s_waitcnt vmcnt(15)
    v_mfma_f32_16x16x32_bf16 v[24:27], v[88:91], v[120:123], v[24:27]
    s_waitcnt vmcnt(14)
    v_mfma_f32_16x16x32_bf16 v[40:43], v[88:91], v[124:127], v[40:43]
    s_waitcnt vmcnt(13)
    v_mfma_f32_16x16x32_bf16 v[56:59], v[88:91], v[128:131], v[56:59]
    s_waitcnt vmcnt(12)
    v_mfma_f32_16x16x32_bf16 v[72:75], v[88:91], v[132:135], v[72:75]
    ds_read_b64_tr_b16 v[88:89], v5 offset:0
    ds_read_b64_tr_b16 v[90:91], v5 offset:2048
    v_mfma_f32_16x16x32_bf16 v[28:31], v[92:95], v[120:123], v[28:31]
    v_mfma_f32_16x16x32_bf16 v[44:47], v[92:95], v[124:127], v[44:47]
    v_mfma_f32_16x16x32_bf16 v[60:63], v[92:95], v[128:131], v[60:63]
    v_mfma_f32_16x16x32_bf16 v[76:79], v[92:95], v[132:135], v[76:79]
    ds_read_b64_tr_b16 v[92:93], v6 offset:0
    ds_read_b64_tr_b16 v[94:95], v6 offset:2048
    v_mfma_f32_16x16x32_bf16 v[32:35], v[96:99], v[120:123], v[32:35]
    v_mfma_f32_16x16x32_bf16 v[48:51], v[96:99], v[124:127], v[48:51]
    v_mfma_f32_16x16x32_bf16 v[64:67], v[96:99], v[128:131], v[64:67]
    v_mfma_f32_16x16x32_bf16 v[80:83], v[96:99], v[132:135], v[80:83]
    ds_read_b64_tr_b16 v[96:97], v7 offset:0
    ds_read_b64_tr_b16 v[98:99], v7 offset:2048
    v_mfma_f32_16x16x32_bf16 v[36:39], v[100:103], v[120:123], v[36:39]
    buffer_load_dwordx4 v[120:123], v3, s[40:43], s62 offen offset:1024 sc1
    v_mfma_f32_16x16x32_bf16 v[52:55], v[100:103], v[124:127], v[52:55]
    buffer_load_dwordx4 v[124:127], v3, s[40:43], s63 offen offset:1024 sc1
    v_mfma_f32_16x16x32_bf16 v[68:71], v[100:103], v[128:131], v[68:71]
    buffer_load_dwordx4 v[128:131], v3, s[40:43], s66 offen offset:1024 sc1
    v_mfma_f32_16x16x32_bf16 v[84:87], v[100:103], v[132:135], v[84:87]
    buffer_load_dwordx4 v[132:135], v3, s[40:43], s67 offen offset:1024 sc1
    ds_read_b64_tr_b16 v[100:101], v8 offset:0
    ds_read_b64_tr_b16 v[102:103], v8 offset:2048
    s_waitcnt vmcnt(15)
    s_waitcnt lgkmcnt(6)
    v_mfma_f32_16x16x32_bf16 v[24:27], v[88:91], v[136:139], v[24:27]
    s_waitcnt vmcnt(14)
    v_mfma_f32_16x16x32_bf16 v[40:43], v[88:91], v[140:143], v[40:43]
    s_waitcnt vmcnt(13)
    v_mfma_f32_16x16x32_bf16 v[56:59], v[88:91], v[144:147], v[56:59]
    s_waitcnt vmcnt(12)
    v_mfma_f32_16x16x32_bf16 v[72:75], v[88:91], v[148:151], v[72:75]
    ds_read_b64_tr_b16 v[88:89], v5 offset:4096
    ds_read_b64_tr_b16 v[90:91], v5 offset:6144
    s_waitcnt lgkmcnt(6)
    v_mfma_f32_16x16x32_bf16 v[28:31], v[92:95], v[136:139], v[28:31]
    v_mfma_f32_16x16x32_bf16 v[44:47], v[92:95], v[140:143], v[44:47]
    v_mfma_f32_16x16x32_bf16 v[60:63], v[92:95], v[144:147], v[60:63]
    v_mfma_f32_16x16x32_bf16 v[76:79], v[92:95], v[148:151], v[76:79]
    ds_read_b64_tr_b16 v[92:93], v6 offset:4096
    ds_read_b64_tr_b16 v[94:95], v6 offset:6144
    s_waitcnt lgkmcnt(6)
    v_mfma_f32_16x16x32_bf16 v[32:35], v[96:99], v[136:139], v[32:35]
    v_mfma_f32_16x16x32_bf16 v[48:51], v[96:99], v[140:143], v[48:51]
    v_mfma_f32_16x16x32_bf16 v[64:67], v[96:99], v[144:147], v[64:67]
    v_mfma_f32_16x16x32_bf16 v[80:83], v[96:99], v[148:151], v[80:83]
    ds_read_b64_tr_b16 v[96:97], v7 offset:4096
    ds_read_b64_tr_b16 v[98:99], v7 offset:6144
    s_waitcnt lgkmcnt(6)
    v_mfma_f32_16x16x32_bf16 v[36:39], v[100:103], v[136:139], v[36:39]
    s_add_u32 s62, s62, 8192
    buffer_load_dwordx4 v[136:139], v3, s[40:43], s62 offen sc1
    v_mfma_f32_16x16x32_bf16 v[52:55], v[100:103], v[140:143], v[52:55]
    s_add_u32 s63, s63, 8192
    buffer_load_dwordx4 v[140:143], v3, s[40:43], s63 offen sc1
    v_mfma_f32_16x16x32_bf16 v[68:71], v[100:103], v[144:147], v[68:71]
    s_add_u32 s66, s66, 8192
    buffer_load_dwordx4 v[144:147], v3, s[40:43], s66 offen sc1
    v_mfma_f32_16x16x32_bf16 v[84:87], v[100:103], v[148:151], v[84:87]
    s_add_u32 s67, s67, 8192
    buffer_load_dwordx4 v[148:151], v3, s[40:43], s67 offen sc1
    ds_read_b64_tr_b16 v[100:101], v8 offset:4096
    ds_read_b64_tr_b16 v[102:103], v8 offset:6144
    s_add_u32 s52, s68, 0x180000
    s_add_u32 m0, s64, 0x0
    s_nop 0
    buffer_load_dwordx4 v4, s[24:27], s52 offen lds
    s_add_u32 s52, s68, 0x182000
    s_add_u32 m0, s64, 0x400
    s_nop 0
    buffer_load_dwordx4 v4, s[24:27], s52 offen lds
    s_add_u32 s52, s68, 0x184000
    s_add_u32 m0, s64, 0x800
    s_nop 0
    buffer_load_dwordx4 v4, s[24:27], s52 offen lds
    s_add_u32 s52, s68, 0x186000
    s_add_u32 m0, s64, 0xc00
    s_nop 0
    buffer_load_dwordx4 v4, s[24:27], s52 offen lds
    s_waitcnt vmcnt(19)
    s_waitcnt lgkmcnt(6)
    v_mfma_f32_16x16x32_bf16 v[24:27], v[88:91], v[152:155], v[24:27]
    s_waitcnt vmcnt(18)
    v_mfma_f32_16x16x32_bf16 v[40:43], v[88:91], v[156:159], v[40:43]
    s_waitcnt vmcnt(17)
    v_mfma_f32_16x16x32_bf16 v[56:59], v[88:91], v[160:163], v[56:59]
    s_waitcnt vmcnt(16)
    v_mfma_f32_16x16x32_bf16 v[72:75], v[88:91], v[164:167], v[72:75]
    ds_read_b64_tr_b16 v[88:89], v5 offset:8192
    ds_read_b64_tr_b16 v[90:91], v5 offset:10240
    s_waitcnt lgkmcnt(6)
    v_mfma_f32_16x16x32_bf16 v[28:31], v[92:95], v[152:155], v[28:31]
    v_mfma_f32_16x16x32_bf16 v[44:47], v[92:95], v[156:159], v[44:47]
    v_mfma_f32_16x16x32_bf16 v[60:63], v[92:95], v[160:163], v[60:63]
    v_mfma_f32_16x16x32_bf16 v[76:79], v[92:95], v[164:167], v[76:79]
    ds_read_b64_tr_b16 v[92:93], v6 offset:8192
    ds_read_b64_tr_b16 v[94:95], v6 offset:10240
    s_waitcnt lgkmcnt(6)
    v_mfma_f32_16x16x32_bf16 v[32:35], v[96:99], v[152:155], v[32:35]
    v_mfma_f32_16x16x32_bf16 v[48:51], v[96:99], v[156:159], v[48:51]
    v_mfma_f32_16x16x32_bf16 v[64:67], v[96:99], v[160:163], v[64:67]
    v_mfma_f32_16x16x32_bf16 v[80:83], v[96:99], v[164:167], v[80:83]
    ds_read_b64_tr_b16 v[96:97], v7 offset:8192
    ds_read_b64_tr_b16 v[98:99], v7 offset:10240
    s_waitcnt lgkmcnt(6)
    v_mfma_f32_16x16x32_bf16 v[36:39], v[100:103], v[152:155], v[36:39]
    buffer_load_dwordx4 v[152:155], v3, s[40:43], s62 offen offset:1024 sc1
    v_mfma_f32_16x16x32_bf16 v[52:55], v[100:103], v[156:159], v[52:55]
    buffer_load_dwordx4 v[156:159], v3, s[40:43], s63 offen offset:1024 sc1
    v_mfma_f32_16x16x32_bf16 v[68:71], v[100:103], v[160:163], v[68:71]
    buffer_load_dwordx4 v[160:163], v3, s[40:43], s66 offen offset:1024 sc1
    v_mfma_f32_16x16x32_bf16 v[84:87], v[100:103], v[164:167], v[84:87]
    buffer_load_dwordx4 v[164:167], v3, s[40:43], s67 offen offset:1024 sc1
    ds_read_b64_tr_b16 v[100:101], v8 offset:8192
    ds_read_b64_tr_b16 v[102:103], v8 offset:10240
    s_add_u32 s52, s68, 0x188000
    s_add_u32 m0, s64, 0x1000
    s_nop 0
    buffer_load_dwordx4 v4, s[24:27], s52 offen lds
    s_add_u32 s52, s68, 0x18a000
    s_add_u32 m0, s64, 0x1400
    s_nop 0
    buffer_load_dwordx4 v4, s[24:27], s52 offen lds
    s_add_u32 s52, s68, 0x18c000
    s_add_u32 m0, s64, 0x1800
    s_nop 0
    buffer_load_dwordx4 v4, s[24:27], s52 offen lds
    s_add_u32 s52, s68, 0x18e000
    s_add_u32 m0, s64, 0x1c00
    s_nop 0
    buffer_load_dwordx4 v4, s[24:27], s52 offen lds
    s_waitcnt vmcnt(23)
    s_waitcnt lgkmcnt(6)
    v_mfma_f32_16x16x32_bf16 v[24:27], v[88:91], v[104:107], v[24:27]
    s_waitcnt vmcnt(22)
    v_mfma_f32_16x16x32_bf16 v[40:43], v[88:91], v[108:111], v[40:43]
    s_waitcnt vmcnt(21)
    v_mfma_f32_16x16x32_bf16 v[56:59], v[88:91], v[112:115], v[56:59]
    s_waitcnt vmcnt(20)
    v_mfma_f32_16x16x32_bf16 v[72:75], v[88:91], v[116:119], v[72:75]
    ds_read_b64_tr_b16 v[88:89], v5 offset:12288
    ds_read_b64_tr_b16 v[90:91], v5 offset:14336
    s_waitcnt lgkmcnt(6)
    v_mfma_f32_16x16x32_bf16 v[28:31], v[92:95], v[104:107], v[28:31]
    v_mfma_f32_16x16x32_bf16 v[44:47], v[92:95], v[108:111], v[44:47]
    v_mfma_f32_16x16x32_bf16 v[60:63], v[92:95], v[112:115], v[60:63]
    v_mfma_f32_16x16x32_bf16 v[76:79], v[92:95], v[116:119], v[76:79]
    ds_read_b64_tr_b16 v[92:93], v6 offset:12288
    ds_read_b64_tr_b16 v[94:95], v6 offset:14336
    s_waitcnt lgkmcnt(6)
    v_mfma_f32_16x16x32_bf16 v[32:35], v[96:99], v[104:107], v[32:35]
    v_mfma_f32_16x16x32_bf16 v[48:51], v[96:99], v[108:111], v[48:51]
    v_mfma_f32_16x16x32_bf16 v[64:67], v[96:99], v[112:115], v[64:67]
    v_mfma_f32_16x16x32_bf16 v[80:83], v[96:99], v[116:119], v[80:83]
    ds_read_b64_tr_b16 v[96:97], v7 offset:12288
    ds_read_b64_tr_b16 v[98:99], v7 offset:14336
    s_waitcnt lgkmcnt(6)
    v_mfma_f32_16x16x32_bf16 v[36:39], v[100:103], v[104:107], v[36:39]
    s_sub_u32 s62, s62, 24576
    buffer_load_dwordx4 v[104:107], v3, s[40:43], s62 offen sc1
    v_mfma_f32_16x16x32_bf16 v[52:55], v[100:103], v[108:111], v[52:55]
    s_sub_u32 s63, s63, 24576
    buffer_load_dwordx4 v[108:111], v3, s[40:43], s63 offen sc1
    v_mfma_f32_16x16x32_bf16 v[68:71], v[100:103], v[112:115], v[68:71]
    s_sub_u32 s66, s66, 24576
    buffer_load_dwordx4 v[112:115], v3, s[40:43], s66 offen sc1
    v_mfma_f32_16x16x32_bf16 v[84:87], v[100:103], v[116:119], v[84:87]
    s_sub_u32 s67, s67, 24576
    buffer_load_dwordx4 v[116:119], v3, s[40:43], s67 offen sc1
    ds_read_b64_tr_b16 v[100:101], v8 offset:12288
    ds_read_b64_tr_b16 v[102:103], v8 offset:14336
    s_waitcnt vmcnt(23)
    s_waitcnt lgkmcnt(6)
    v_mfma_f32_16x16x32_bf16 v[24:27], v[88:91], v[120:123], v[24:27]
    s_waitcnt vmcnt(22)
    v_mfma_f32_16x16x32_bf16 v[40:43], v[88:91], v[124:127], v[40:43]
    s_waitcnt vmcnt(21)
    v_mfma_f32_16x16x32_bf16 v[56:59], v[88:91], v[128:131], v[56:59]
    s_waitcnt vmcnt(20)
    v_mfma_f32_16x16x32_bf16 v[72:75], v[88:91], v[132:135], v[72:75]
    ds_read_b64_tr_b16 v[88:89], v5 offset:16384
    ds_read_b64_tr_b16 v[90:91], v5 offset:18432
    s_waitcnt lgkmcnt(6)
    v_mfma_f32_16x16x32_bf16 v[28:31], v[92:95], v[120:123], v[28:31]
    v_mfma_f32_16x16x32_bf16 v[44:47], v[92:95], v[124:127], v[44:47]
    v_mfma_f32_16x16x32_bf16 v[60:63], v[92:95], v[128:131], v[60:63]
    v_mfma_f32_16x16x32_bf16 v[76:79], v[92:95], v[132:135], v[76:79]
    ds_read_b64_tr_b16 v[92:93], v6 offset:16384
    ds_read_b64_tr_b16 v[94:95], v6 offset:18432
    s_waitcnt lgkmcnt(6)
    v_mfma_f32_16x16x32_bf16 v[32:35], v[96:99], v[120:123], v[32:35]
    v_mfma_f32_16x16x32_bf16 v[48:51], v[96:99], v[124:127], v[48:51]
    v_mfma_f32_16x16x32_bf16 v[64:67], v[96:99], v[128:131], v[64:67]
    v_mfma_f32_16x16x32_bf16 v[80:83], v[96:99], v[132:135], v[80:83]
    ds_read_b64_tr_b16 v[96:97], v7 offset:16384
    ds_read_b64_tr_b16 v[98:99], v7 offset:18432
    s_waitcnt lgkmcnt(6)
    v_mfma_f32_16x16x32_bf16 v[36:39], v[100:103], v[120:123], v[36:39]
    buffer_load_dwordx4 v[120:123], v3, s[40:43], s62 offen offset:1024 sc1
    v_mfma_f32_16x16x32_bf16 v[52:55], v[100:103], v[124:127], v[52:55]
    buffer_load_dwordx4 v[124:127], v3, s[40:43], s63 offen offset:1024 sc1
    v_mfma_f32_16x16x32_bf16 v[68:71], v[100:103], v[128:131], v[68:71]
    buffer_load_dwordx4 v[128:131], v3, s[40:43], s66 offen offset:1024 sc1
    v_mfma_f32_16x16x32_bf16 v[84:87], v[100:103], v[132:135], v[84:87]
    buffer_load_dwordx4 v[132:135], v3, s[40:43], s67 offen offset:1024 sc1
    ds_read_b64_tr_b16 v[100:101], v8 offset:16384
    ds_read_b64_tr_b16 v[102:103], v8 offset:18432
    s_waitcnt vmcnt(23)
    s_waitcnt lgkmcnt(6)
    v_mfma_f32_16x16x32_bf16 v[24:27], v[88:91], v[136:139], v[24:27]
    s_waitcnt vmcnt(22)
    v_mfma_f32_16x16x32_bf16 v[40:43], v[88:91], v[140:143], v[40:43]
    s_waitcnt vmcnt(21)
    v_mfma_f32_16x16x32_bf16 v[56:59], v[88:91], v[144:147], v[56:59]
    s_waitcnt vmcnt(20)
    v_mfma_f32_16x16x32_bf16 v[72:75], v[88:91], v[148:151], v[72:75]
    ds_read_b64_tr_b16 v[88:89], v5 offset:20480
    ds_read_b64_tr_b16 v[90:91], v5 offset:22528
    s_waitcnt lgkmcnt(6)
    v_mfma_f32_16x16x32_bf16 v[28:31], v[92:95], v[136:139], v[28:31]
    v_mfma_f32_16x16x32_bf16 v[44:47], v[92:95], v[140:143], v[44:47]
    v_mfma_f32_16x16x32_bf16 v[60:63], v[92:95], v[144:147], v[60:63]
    v_mfma_f32_16x16x32_bf16 v[76:79], v[92:95], v[148:151], v[76:79]
    ds_read_b64_tr_b16 v[92:93], v6 offset:20480
    ds_read_b64_tr_b16 v[94:95], v6 offset:22528
    s_waitcnt lgkmcnt(6)
    v_mfma_f32_16x16x32_bf16 v[32:35], v[96:99], v[136:139], v[32:35]
    v_mfma_f32_16x16x32_bf16 v[48:51], v[96:99], v[140:143], v[48:51]
    v_mfma_f32_16x16x32_bf16 v[64:67], v[96:99], v[144:147], v[64:67]
    v_mfma_f32_16x16x32_bf16 v[80:83], v[96:99], v[148:151], v[80:83]
    ds_read_b64_tr_b16 v[96:97], v7 offset:20480
    ds_read_b64_tr_b16 v[98:99], v7 offset:22528
    s_waitcnt lgkmcnt(6)
    v_mfma_f32_16x16x32_bf16 v[36:39], v[100:103], v[136:139], v[36:39]
    s_sub_u32 s62, s62, 8192
    buffer_load_dwordx4 v[136:139], v3, s[40:43], s62 offen sc1
    v_mfma_f32_16x16x32_bf16 v[52:55], v[100:103], v[140:143], v[52:55]
    s_sub_u32 s63, s63, 8192
    buffer_load_dwordx4 v[140:143], v3, s[40:43], s63 offen sc1
    v_mfma_f32_16x16x32_bf16 v[68:71], v[100:103], v[144:147], v[68:71]
    s_sub_u32 s66, s66, 8192
    buffer_load_dwordx4 v[144:147], v3, s[40:43], s66 offen sc1
    v_mfma_f32_16x16x32_bf16 v[84:87], v[100:103], v[148:151], v[84:87]
    s_sub_u32 s67, s67, 8192
    buffer_load_dwordx4 v[148:151], v3, s[40:43], s67 offen sc1
    ds_read_b64_tr_b16 v[100:101], v8 offset:20480
    ds_read_b64_tr_b16 v[102:103], v8 offset:22528
    s_waitcnt vmcnt(19)
    s_waitcnt lgkmcnt(6)
    v_mfma_f32_16x16x32_bf16 v[24:27], v[88:91], v[152:155], v[24:27]
    s_waitcnt vmcnt(18)
    v_mfma_f32_16x16x32_bf16 v[40:43], v[88:91], v[156:159], v[40:43]
    s_waitcnt vmcnt(17)
    v_mfma_f32_16x16x32_bf16 v[56:59], v[88:91], v[160:163], v[56:59]
    s_waitcnt vmcnt(16)
    v_mfma_f32_16x16x32_bf16 v[72:75], v[88:91], v[164:167], v[72:75]
    ds_read_b64_tr_b16 v[88:89], v5 offset:24576
    ds_read_b64_tr_b16 v[90:91], v5 offset:26624
    s_waitcnt lgkmcnt(6)
    v_mfma_f32_16x16x32_bf16 v[28:31], v[92:95], v[152:155], v[28:31]
    v_mfma_f32_16x16x32_bf16 v[44:47], v[92:95], v[156:159], v[44:47]
    v_mfma_f32_16x16x32_bf16 v[60:63], v[92:95], v[160:163], v[60:63]
    v_mfma_f32_16x16x32_bf16 v[76:79], v[92:95], v[164:167], v[76:79]
    ds_read_b64_tr_b16 v[92:93], v6 offset:24576
    ds_read_b64_tr_b16 v[94:95], v6 offset:26624
    s_waitcnt lgkmcnt(6)
    v_mfma_f32_16x16x32_bf16 v[32:35], v[96:99], v[152:155], v[32:35]
    v_mfma_f32_16x16x32_bf16 v[48:51], v[96:99], v[156:159], v[48:51]
    v_mfma_f32_16x16x32_bf16 v[64:67], v[96:99], v[160:163], v[64:67]
    v_mfma_f32_16x16x32_bf16 v[80:83], v[96:99], v[164:167], v[80:83]
    ds_read_b64_tr_b16 v[96:97], v7 offset:24576
    ds_read_b64_tr_b16 v[98:99], v7 offset:26624
    s_waitcnt lgkmcnt(6)
    v_mfma_f32_16x16x32_bf16 v[36:39], v[100:103], v[152:155], v[36:39]
    buffer_load_dwordx4 v[152:155], v3, s[40:43], s62 offen offset:1024 sc1
    v_mfma_f32_16x16x32_bf16 v[52:55], v[100:103], v[156:159], v[52:55]
    buffer_load_dwordx4 v[156:159], v3, s[40:43], s63 offen offset:1024 sc1
    v_mfma_f32_16x16x32_bf16 v[68:71], v[100:103], v[160:163], v[68:71]
    buffer_load_dwordx4 v[160:163], v3, s[40:43], s66 offen offset:1024 sc1
    v_mfma_f32_16x16x32_bf16 v[84:87], v[100:103], v[164:167], v[84:87]
    buffer_load_dwordx4 v[164:167], v3, s[40:43], s67 offen offset:1024 sc1
    ds_read_b64_tr_b16 v[100:101], v8 offset:24576
    ds_read_b64_tr_b16 v[102:103], v8 offset:26624
    s_waitcnt vmcnt(15)
    s_waitcnt lgkmcnt(6)
    v_mfma_f32_16x16x32_bf16 v[24:27], v[88:91], v[104:107], v[24:27]
    s_waitcnt vmcnt(14)
    v_mfma_f32_16x16x32_bf16 v[40:43], v[88:91], v[108:111], v[40:43]
    s_waitcnt vmcnt(13)
    v_mfma_f32_16x16x32_bf16 v[56:59], v[88:91], v[112:115], v[56:59]
    s_waitcnt vmcnt(12)
    v_mfma_f32_16x16x32_bf16 v[72:75], v[88:91], v[116:119], v[72:75]
    ds_read_b64_tr_b16 v[88:89], v5 offset:28672
    ds_read_b64_tr_b16 v[90:91], v5 offset:30720
    s_waitcnt lgkmcnt(6)
    v_mfma_f32_16x16x32_bf16 v[28:31], v[92:95], v[104:107], v[28:31]
    v_mfma_f32_16x16x32_bf16 v[44:47], v[92:95], v[108:111], v[44:47]
    v_mfma_f32_16x16x32_bf16 v[60:63], v[92:95], v[112:115], v[60:63]
    v_mfma_f32_16x16x32_bf16 v[76:79], v[92:95], v[116:119], v[76:79]
    ds_read_b64_tr_b16 v[92:93], v6 offset:28672
    ds_read_b64_tr_b16 v[94:95], v6 offset:30720
    s_waitcnt lgkmcnt(6)
    v_mfma_f32_16x16x32_bf16 v[32:35], v[96:99], v[104:107], v[32:35]
    v_mfma_f32_16x16x32_bf16 v[48:51], v[96:99], v[108:111], v[48:51]
    v_mfma_f32_16x16x32_bf16 v[64:67], v[96:99], v[112:115], v[64:67]
    v_mfma_f32_16x16x32_bf16 v[80:83], v[96:99], v[116:119], v[80:83]
    ds_read_b64_tr_b16 v[96:97], v7 offset:28672
    ds_read_b64_tr_b16 v[98:99], v7 offset:30720
    s_waitcnt lgkmcnt(6)
    v_mfma_f32_16x16x32_bf16 v[36:39], v[100:103], v[104:107], v[36:39]
    s_add_u32 s62, s62, 40960
    buffer_load_dwordx4 v[104:107], v3, s[40:43], s62 offen sc1
    v_mfma_f32_16x16x32_bf16 v[52:55], v[100:103], v[108:111], v[52:55]
    s_add_u32 s63, s63, 40960
    buffer_load_dwordx4 v[108:111], v3, s[40:43], s63 offen sc1
    v_mfma_f32_16x16x32_bf16 v[68:71], v[100:103], v[112:115], v[68:71]
    s_add_u32 s66, s66, 40960
    buffer_load_dwordx4 v[112:115], v3, s[40:43], s66 offen sc1
    v_mfma_f32_16x16x32_bf16 v[84:87], v[100:103], v[116:119], v[84:87]
    s_add_u32 s67, s67, 40960
    buffer_load_dwordx4 v[116:119], v3, s[40:43], s67 offen sc1
    ds_read_b64_tr_b16 v[100:101], v8 offset:28672
    ds_read_b64_tr_b16 v[102:103], v8 offset:30720
    s_waitcnt vmcnt(15)
    s_waitcnt lgkmcnt(6)
    v_mfma_f32_16x16x32_bf16 v[24:27], v[88:91], v[120:123], v[24:27]
    s_waitcnt vmcnt(14)
    v_mfma_f32_16x16x32_bf16 v[40:43], v[88:91], v[124:127], v[40:43]
    s_waitcnt vmcnt(13)
    v_mfma_f32_16x16x32_bf16 v[56:59], v[88:91], v[128:131], v[56:59]
    s_waitcnt vmcnt(12)
    v_mfma_f32_16x16x32_bf16 v[72:75], v[88:91], v[132:135], v[72:75]
    ds_read_b64_tr_b16 v[88:89], v12 offset:0
    ds_read_b64_tr_b16 v[90:91], v12 offset:2048
    s_waitcnt lgkmcnt(6)
    v_mfma_f32_16x16x32_bf16 v[28:31], v[92:95], v[120:123], v[28:31]
    v_mfma_f32_16x16x32_bf16 v[44:47], v[92:95], v[124:127], v[44:47]
    v_mfma_f32_16x16x32_bf16 v[60:63], v[92:95], v[128:131], v[60:63]
    v_mfma_f32_16x16x32_bf16 v[76:79], v[92:95], v[132:135], v[76:79]
    ds_read_b64_tr_b16 v[92:93], v13 offset:0
    ds_read_b64_tr_b16 v[94:95], v13 offset:2048
    s_waitcnt lgkmcnt(6)
    v_mfma_f32_16x16x32_bf16 v[32:35], v[96:99], v[120:123], v[32:35]
    v_mfma_f32_16x16x32_bf16 v[48:51], v[96:99], v[124:127], v[48:51]
    v_mfma_f32_16x16x32_bf16 v[64:67], v[96:99], v[128:131], v[64:67]
    v_mfma_f32_16x16x32_bf16 v[80:83], v[96:99], v[132:135], v[80:83]
    ds_read_b64_tr_b16 v[96:97], v14 offset:0
    ds_read_b64_tr_b16 v[98:99], v14 offset:2048
    s_waitcnt lgkmcnt(6)
    v_mfma_f32_16x16x32_bf16 v[36:39], v[100:103], v[120:123], v[36:39]
    buffer_load_dwordx4 v[120:123], v3, s[40:43], s62 offen offset:1024 sc1
    v_mfma_f32_16x16x32_bf16 v[52:55], v[100:103], v[124:127], v[52:55]
    buffer_load_dwordx4 v[124:127], v3, s[40:43], s63 offen offset:1024 sc1
    v_mfma_f32_16x16x32_bf16 v[68:71], v[100:103], v[128:131], v[68:71]
    buffer_load_dwordx4 v[128:131], v3, s[40:43], s66 offen offset:1024 sc1
    v_mfma_f32_16x16x32_bf16 v[84:87], v[100:103], v[132:135], v[84:87]
    buffer_load_dwordx4 v[132:135], v3, s[40:43], s67 offen offset:1024 sc1
    ds_read_b64_tr_b16 v[100:101], v15 offset:0
    ds_read_b64_tr_b16 v[102:103], v15 offset:2048
    s_waitcnt vmcnt(15)
    s_waitcnt lgkmcnt(6)
    v_mfma_f32_16x16x32_bf16 v[24:27], v[88:91], v[136:139], v[24:27]
    s_waitcnt vmcnt(14)
    v_mfma_f32_16x16x32_bf16 v[40:43], v[88:91], v[140:143], v[40:43]
    s_waitcnt vmcnt(13)
    v_mfma_f32_16x16x32_bf16 v[56:59], v[88:91], v[144:147], v[56:59]
    s_waitcnt vmcnt(12)
    v_mfma_f32_16x16x32_bf16 v[72:75], v[88:91], v[148:151], v[72:75]
    ds_read_b64_tr_b16 v[88:89], v12 offset:4096
    ds_read_b64_tr_b16 v[90:91], v12 offset:6144
    s_waitcnt lgkmcnt(6)
    v_mfma_f32_16x16x32_bf16 v[28:31], v[92:95], v[136:139], v[28:31]
    v_mfma_f32_16x16x32_bf16 v[44:47], v[92:95], v[140:143], v[44:47]
    v_mfma_f32_16x16x32_bf16 v[60:63], v[92:95], v[144:147], v[60:63]
    v_mfma_f32_16x16x32_bf16 v[76:79], v[92:95], v[148:151], v[76:79]
    ds_read_b64_tr_b16 v[92:93], v13 offset:4096
    ds_read_b64_tr_b16 v[94:95], v13 offset:6144
    s_waitcnt lgkmcnt(6)
    v_mfma_f32_16x16x32_bf16 v[32:35], v[96:99], v[136:139], v[32:35]
    v_mfma_f32_16x16x32_bf16 v[48:51], v[96:99], v[140:143], v[48:51]
    v_mfma_f32_16x16x32_bf16 v[64:67], v[96:99], v[144:147], v[64:67]
    v_mfma_f32_16x16x32_bf16 v[80:83], v[96:99], v[148:151], v[80:83]
    ds_read_b64_tr_b16 v[96:97], v14 offset:4096
    ds_read_b64_tr_b16 v[98:99], v14 offset:6144
    s_waitcnt lgkmcnt(6)
    v_mfma_f32_16x16x32_bf16 v[36:39], v[100:103], v[136:139], v[36:39]
    v_mfma_f32_16x16x32_bf16 v[52:55], v[100:103], v[140:143], v[52:55]
    v_mfma_f32_16x16x32_bf16 v[68:71], v[100:103], v[144:147], v[68:71]
    v_mfma_f32_16x16x32_bf16 v[84:87], v[100:103], v[148:151], v[84:87]
    ds_read_b64_tr_b16 v[100:101], v15 offset:4096
    ds_read_b64_tr_b16 v[102:103], v15 offset:6144
    s_waitcnt vmcnt(11)
    s_waitcnt lgkmcnt(6)
    v_mfma_f32_16x16x32_bf16 v[24:27], v[88:91], v[152:155], v[24:27]
    s_waitcnt vmcnt(10)
    v_mfma_f32_16x16x32_bf16 v[40:43], v[88:91], v[156:159], v[40:43]
    s_waitcnt vmcnt(9)
    v_mfma_f32_16x16x32_bf16 v[56:59], v[88:91], v[160:163], v[56:59]
    s_waitcnt vmcnt(8)
    v_mfma_f32_16x16x32_bf16 v[72:75], v[88:91], v[164:167], v[72:75]
    ds_read_b64_tr_b16 v[88:89], v5 offset:0
    ds_read_b64_tr_b16 v[90:91], v5 offset:2048
    s_waitcnt lgkmcnt(6)
    v_mfma_f32_16x16x32_bf16 v[28:31], v[92:95], v[152:155], v[28:31]
    v_mfma_f32_16x16x32_bf16 v[44:47], v[92:95], v[156:159], v[44:47]
    v_mfma_f32_16x16x32_bf16 v[60:63], v[92:95], v[160:163], v[60:63]
    v_mfma_f32_16x16x32_bf16 v[76:79], v[92:95], v[164:167], v[76:79]
    ds_read_b64_tr_b16 v[92:93], v6 offset:0
    ds_read_b64_tr_b16 v[94:95], v6 offset:2048
    s_waitcnt lgkmcnt(6)
    v_mfma_f32_16x16x32_bf16 v[32:35], v[96:99], v[152:155], v[32:35]
    v_mfma_f32_16x16x32_bf16 v[48:51], v[96:99], v[156:159], v[48:51]
    v_mfma_f32_16x16x32_bf16 v[64:67], v[96:99], v[160:163], v[64:67]
    v_mfma_f32_16x16x32_bf16 v[80:83], v[96:99], v[164:167], v[80:83]
    ds_read_b64_tr_b16 v[96:97], v7 offset:0
    ds_read_b64_tr_b16 v[98:99], v7 offset:2048
    s_waitcnt lgkmcnt(6)
    v_mfma_f32_16x16x32_bf16 v[36:39], v[100:103], v[152:155], v[36:39]
    v_mfma_f32_16x16x32_bf16 v[52:55], v[100:103], v[156:159], v[52:55]
    v_mfma_f32_16x16x32_bf16 v[68:71], v[100:103], v[160:163], v[68:71]
    v_mfma_f32_16x16x32_bf16 v[84:87], v[100:103], v[164:167], v[84:87]
    ds_read_b64_tr_b16 v[100:101], v8 offset:0
    ds_read_b64_tr_b16 v[102:103], v8 offset:2048
    s_waitcnt vmcnt(7)
    s_waitcnt lgkmcnt(6)
    v_mfma_f32_16x16x32_bf16 v[24:27], v[88:91], v[104:107], v[24:27]
    s_waitcnt vmcnt(6)
    v_mfma_f32_16x16x32_bf16 v[40:43], v[88:91], v[108:111], v[40:43]
    s_waitcnt vmcnt(5)
    v_mfma_f32_16x16x32_bf16 v[56:59], v[88:91], v[112:115], v[56:59]
    s_waitcnt vmcnt(4)
    v_mfma_f32_16x16x32_bf16 v[72:75], v[88:91], v[116:119], v[72:75]
    ds_read_b64_tr_b16 v[88:89], v5 offset:4096
    ds_read_b64_tr_b16 v[90:91], v5 offset:6144
    s_waitcnt lgkmcnt(6)
    v_mfma_f32_16x16x32_bf16 v[28:31], v[92:95], v[104:107], v[28:31]
    v_mfma_f32_16x16x32_bf16 v[44:47], v[92:95], v[108:111], v[44:47]
    v_mfma_f32_16x16x32_bf16 v[60:63], v[92:95], v[112:115], v[60:63]
    v_mfma_f32_16x16x32_bf16 v[76:79], v[92:95], v[116:119], v[76:79]
    ds_read_b64_tr_b16 v[92:93], v6 offset:4096
    ds_read_b64_tr_b16 v[94:95], v6 offset:6144
    v_add_u32 v13, 64, v10
    v_bfi_b32 v13, s69, v13, v10
    s_waitcnt lgkmcnt(6)
    v_mfma_f32_16x16x32_bf16 v[32:35], v[96:99], v[104:107], v[32:35]
    v_mfma_f32_16x16x32_bf16 v[48:51], v[96:99], v[108:111], v[48:51]
    v_mfma_f32_16x16x32_bf16 v[64:67], v[96:99], v[112:115], v[64:67]
    v_mfma_f32_16x16x32_bf16 v[80:83], v[96:99], v[116:119], v[80:83]
    ds_read_b64_tr_b16 v[96:97], v7 offset:4096
    ds_read_b64_tr_b16 v[98:99], v7 offset:6144
    v_add_u32 v14, 0x80, v10
    v_bfi_b32 v14, s69, v14, v10
    s_waitcnt lgkmcnt(6)
    v_mfma_f32_16x16x32_bf16 v[36:39], v[100:103], v[104:107], v[36:39]
    v_mfma_f32_16x16x32_bf16 v[52:55], v[100:103], v[108:111], v[52:55]
    v_mfma_f32_16x16x32_bf16 v[68:71], v[100:103], v[112:115], v[68:71]
    v_mfma_f32_16x16x32_bf16 v[84:87], v[100:103], v[116:119], v[84:87]
    ds_read_b64_tr_b16 v[100:101], v8 offset:4096
    ds_read_b64_tr_b16 v[102:103], v8 offset:6144
    v_add_u32 v15, 0xc0, v10
    v_bfi_b32 v15, s69, v15, v10
    s_waitcnt vmcnt(3)
    s_waitcnt lgkmcnt(6)
    v_mfma_f32_16x16x32_bf16 v[24:27], v[88:91], v[120:123], v[24:27]
    s_waitcnt lgkmcnt(4)
    v_mfma_f32_16x16x32_bf16 v[28:31], v[92:95], v[120:123], v[28:31]
    s_waitcnt lgkmcnt(2)
    v_mfma_f32_16x16x32_bf16 v[32:35], v[96:99], v[120:123], v[32:35]
    s_waitcnt lgkmcnt(0)
    v_mfma_f32_16x16x32_bf16 v[36:39], v[100:103], v[120:123], v[36:39]
    s_waitcnt vmcnt(2)
    v_mfma_f32_16x16x32_bf16 v[40:43], v[88:91], v[124:127], v[40:43]
    v_mfma_f32_16x16x32_bf16 v[44:47], v[92:95], v[124:127], v[44:47]
    v_mfma_f32_16x16x32_bf16 v[48:51], v[96:99], v[124:127], v[48:51]
    v_mfma_f32_16x16x32_bf16 v[52:55], v[100:103], v[124:127], v[52:55]
    ds_write_b128 v10, v[24:27] offset:16384
    ds_write_b128 v13, v[28:31] offset:17408
    ds_write_b128 v14, v[32:35] offset:18432
    ds_write_b128 v15, v[36:39] offset:19456
    s_waitcnt vmcnt(1)
    v_mfma_f32_16x16x32_bf16 v[56:59], v[88:91], v[128:131], v[56:59]
    v_mfma_f32_16x16x32_bf16 v[60:63], v[92:95], v[128:131], v[60:63]
    v_mfma_f32_16x16x32_bf16 v[64:67], v[96:99], v[128:131], v[64:67]
    v_mfma_f32_16x16x32_bf16 v[68:71], v[100:103], v[128:131], v[68:71]
    ds_write_b128 v10, v[40:43] offset:20480
    ds_write_b128 v13, v[44:47] offset:21504
    ds_write_b128 v14, v[48:51] offset:22528
    ds_write_b128 v15, v[52:55] offset:23552
    s_waitcnt vmcnt(0)
    v_mfma_f32_16x16x32_bf16 v[72:75], v[88:91], v[132:135], v[72:75]
    v_mfma_f32_16x16x32_bf16 v[76:79], v[92:95], v[132:135], v[76:79]
    v_mfma_f32_16x16x32_bf16 v[80:83], v[96:99], v[132:135], v[80:83]
    v_mfma_f32_16x16x32_bf16 v[84:87], v[100:103], v[132:135], v[84:87]
    ds_write_b128 v10, v[56:59] offset:24576
    ds_write_b128 v13, v[60:63] offset:25600
    ds_write_b128 v14, v[64:67] offset:26624
    ds_write_b128 v15, v[68:71] offset:27648
    s_nop 0
    ds_write_b128 v10, v[72:75] offset:28672
    ds_write_b128 v13, v[76:79] offset:29696
    ds_write_b128 v14, v[80:83] offset:30720
    ds_write_b128 v15, v[84:87] offset:31744
    s_waitcnt lgkmcnt(0)
fused_kernel_j431:
    s_barrier
    ds_read_b128 v[24:27], v11 offset:0
    ds_read_b128 v[28:31], v11 offset:256
    ds_read_b128 v[32:35], v11 offset:32768
    ds_read_b128 v[36:39], v11 offset:33024
    ds_read_b128 v[40:43], v1 offset:0
    ds_read_b128 v[44:47], v1 offset:256
    ds_read_b128 v[48:51], v2 offset:0
    ds_read_b128 v[52:55], v2 offset:256
    s_waitcnt lgkmcnt(4)
    v_pk_add_f32 v[24:25], v[24:25], v[32:33]
    v_pk_add_f32 v[26:27], v[26:27], v[34:35]
    v_pk_add_f32 v[28:29], v[28:29], v[36:37]
    v_pk_add_f32 v[30:31], v[30:31], v[38:39]
    s_waitcnt lgkmcnt(2)
    v_pk_add_f32 v[24:25], v[24:25], v[40:41]
    v_pk_add_f32 v[26:27], v[26:27], v[42:43]
    v_pk_add_f32 v[28:29], v[28:29], v[44:45]
    v_pk_add_f32 v[30:31], v[30:31], v[46:47]
    s_waitcnt lgkmcnt(0)
    v_pk_add_f32 v[24:25], v[24:25], v[48:49]
    v_pk_add_f32 v[26:27], v[26:27], v[50:51]
    v_pk_add_f32 v[28:29], v[28:29], v[52:53]
    v_pk_add_f32 v[30:31], v[30:31], v[54:55]
    v_cvt_pk_bf16_f32 v56, 0, v24
    v_cvt_pk_bf16_f32 v57, 0, v25
    v_cvt_pk_bf16_f32 v58, 0, v26
    v_cvt_pk_bf16_f32 v59, 0, v27
    v_lshlrev_b32 v60, 16, v20
    v_and_b32 v61, 0xffff0000, v20
    v_lshlrev_b32 v62, 16, v21
    v_and_b32 v63, 0xffff0000, v21
    v_pk_add_f32 v[56:57], v[56:57], v[60:61]
    v_pk_add_f32 v[58:59], v[58:59], v[62:63]
    v_cvt_pk_bf16_f32 v56, 0, v56
    v_cvt_pk_bf16_f32 v57, 0, v57
    v_cvt_pk_bf16_f32 v58, 0, v58
    v_cvt_pk_bf16_f32 v59, 0, v59
    v_lshlrev_b32 v60, 16, v16
    v_and_b32 v61, 0xffff0000, v16
    v_lshlrev_b32 v62, 16, v17
    v_and_b32 v63, 0xffff0000, v17
    v_pk_add_f32 v[56:57], v[60:61], v[56:57]
    v_pk_add_f32 v[58:59], v[62:63], v[58:59]
    v_cvt_pk_bf16_f32 v68, v56, v57
    v_cvt_pk_bf16_f32 v69, v58, v59
    v_cvt_pk_bf16_f32 v56, 0, v28
    v_cvt_pk_bf16_f32 v57, 0, v29
    v_cvt_pk_bf16_f32 v58, 0, v30
    v_cvt_pk_bf16_f32 v59, 0, v31
    v_lshlrev_b32 v60, 16, v22
    v_and_b32 v61, 0xffff0000, v22
    v_lshlrev_b32 v62, 16, v23
    v_and_b32 v63, 0xffff0000, v23
    v_pk_add_f32 v[56:57], v[56:57], v[60:61]
    v_pk_add_f32 v[58:59], v[58:59], v[62:63]
    v_cvt_pk_bf16_f32 v56, 0, v56
    v_cvt_pk_bf16_f32 v57, 0, v57
    v_cvt_pk_bf16_f32 v58, 0, v58
    v_cvt_pk_bf16_f32 v59, 0, v59
    v_lshlrev_b32 v60, 16, v18
    v_and_b32 v61, 0xffff0000, v18
    v_lshlrev_b32 v62, 16, v19
    v_and_b32 v63, 0xffff0000, v19
    v_pk_add_f32 v[56:57], v[60:61], v[56:57]
    v_pk_add_f32 v[58:59], v[62:63], v[58:59]
    v_cvt_pk_bf16_f32 v70, v56, v57
    v_cvt_pk_bf16_f32 v71, v58, v59
    buffer_store_dwordx4 v[68:71], v9, s[32:35], 0 offen sc0 sc1 nt
    s_endpgm
fused_kernel_cfallback:
    s_mov_b32 s47, 1
    s_waitcnt vmcnt(0) lgkmcnt(0)
    s_barrier
    s_barrier
    s_branch fused_kernel_cstart
fused_kernel_helper:
    s_sub_u32 s57, s44, 8
    s_mul_i32 s58, s57, 49152
    s_lshl_b32 s60, s57, 10
    s_lshl_b32 s61, s57, 13
    v_lshlrev_b32 v13, 2, v1
    v_lshlrev_b32 v12, 7, v1
    v_mov_b32 v14, 0
    v_lshrrev_b32 v5, 2, v1
    v_and_b32 v6, 3, v1
    v_lshrrev_b32 v7, 3, v5
    v_lshlrev_b32 v7, 1, v7
    v_xor_b32 v6, v6, v7
    v_mul_u32_u24 v9, 0xc00, v5
    v_lshl_add_u32 v9, v6, 4, v9
    s_lshl_b32 s50, s56, 6
    v_add_u32 v9, s50, v9
    v_lshrrev_b32 v5, 3, v1
    v_and_b32 v6, 7, v1
    v_bfe_u32 v7, v5, 1, 2
    v_lshlrev_b32 v7, 1, v7
    v_xor_b32 v6, v6, v7
    v_lshlrev_b32 v10, 10, v5
    v_lshl_add_u32 v10, v6, 4, v10
    s_lshl_b32 s50, s59, 7
    v_add_u32 v10, s50, v10
    s_mul_i32 s51, s56, 224
    s_and_b32 s50, s51, 0xffffffc0
    v_lshrrev_b32 v5, 4, v1
    s_lshl_b32 s52, s57, 2
    v_add_u32 v5, s52, v5
    v_and_b32 v6, 7, v5
    v_lshlrev_b32 v6, 1, v6
    v_and_b32 v7, 15, v1
    v_xor_b32 v7, v7, v6
    v_mul_u32_u24 v11, 3584, v5
    v_lshl_add_u32 v11, v7, 4, v11
    v_add_u32 v11, s50, v11
    s_waitcnt lgkmcnt(0)
    s_and_b32 s5, s5, 0xffff
    s_and_b32 s9, s9, 0xffff
    s_and_b32 s13, s13, 0xffff
    s_and_b32 s17, s17, 0xffff
    s_and_b32 s21, s21, 0xffff
    s_and_b32 s25, s25, 0xffff
    s_and_b32 s29, s29, 0xffff
    s_and_b32 s33, s33, 0xffff
    s_and_b32 s37, s37, 0xffff
    s_and_b32 s41, s41, 0xffff
    s_mov_b32 s74, s40
    s_mov_b32 s75, s41
    s_getpc_b64 s[76:77]
fused_kernel_pc:
    s_sub_u32 s76, s76, fused_kernel_pc-fused_kernel
    s_subb_u32 s77, s77, 0
    s_and_b32 s77, s77, 0xffff
    s_mov_b32 s78, fused_kernel_done-fused_kernel
    s_mov_b32 s79, 0x20000
    s_cmp_lg_u32 s57, 1
    s_cbranch_scc1 fused_kernel_h132
    s_cmp_ge_u32 s46, 16
    s_cbranch_scc1 fused_kernel_h132
    v_mov_b32 v20, -1
    v_mov_b32 v21, -1
    v_mov_b32 v22, -1
    v_mov_b32 v23, -1
    s_and_b32 s50, s46, 7
    s_lshl_b32 s50, s50, 5
    s_lshl_b32 s51, s45, 1
    s_add_u32 s50, s50, s51
    s_lshr_b32 s51, s46, 3
    s_add_u32 s50, s50, s51
    s_lshl_b32 s50, s50, 12
    s_add_u32 s50, s50, 0x1000000
    s_add_u32 s51, s50, 65536
    buffer_store_dwordx4 v[20:23], v3, s[40:43], s50 offen sc1
    buffer_store_dwordx4 v[20:23], v3, s[40:43], s50 offen offset:1024 sc1
    buffer_store_dwordx4 v[20:23], v3, s[40:43], s51 offen sc1
    buffer_store_dwordx4 v[20:23], v3, s[40:43], s51 offen offset:1024 sc1
    s_mov_b64 exec, 0xff
    buffer_store_dwordx4 v[20:23], v3, s[40:43], s50 offen offset:2048 sc1
    buffer_store_dwordx4 v[20:23], v3, s[40:43], s51 offen offset:2048 sc1
    s_cmp_lg_u32 s46, 0
    s_cbranch_scc1 fused_kernel_z33
    s_lshl_b32 s50, s45, 21
    s_add_u32 s50, s50, 0x120000
    buffer_store_dword v14, v13, s[40:43], s50 offen
fused_kernel_z33:
    s_mov_b64 exec, -1
fused_kernel_h132:
    s_cmp_eq_u32 s49, 0
    s_cbranch_scc1 fused_kernel_good34
    s_cmp_lg_u32 s57, 1
    s_cbranch_scc1 fused_kernel_h135
    v_mov_b32 v16, 0x10000
    s_mov_b64 exec, 1
    buffer_atomic_add v16, v14, s[36:39], 0 offen offset:128 sc1
    s_mov_b64 exec, -1
fused_kernel_h135:
    s_branch fused_kernel_hfallback
fused_kernel_good34:
fused_kernel_hstart:
    s_cmp_lg_u32 s57, 2
    s_cbranch_scc1 fused_kernel_h236
    s_and_b32 s50, s46, 31
    s_mul_i32 s50, s50, 1280
    v_add_u32 v5, s50, v12
    s_mov_b64 exec, 0x3ff
    buffer_load_dword v17, v5, s[76:79], 0 offen
    s_mov_b64 exec, -1
fused_kernel_h236:
    s_cmp_lg_u32 s57, 3
    s_cbranch_scc1 fused_kernel_h337
    s_mov_b64 exec, 7
    s_mul_i32 s50, s56, 224
    v_mul_u32_u24 v5, 110, v1
    buffer_load_ubyte v17, v5, s[20:23], s50 offen
    s_mov_b64 exec, 1
    s_lshl_b32 s50, s59, 7
    buffer_load_dword v17, v14, s[28:31], s50 offen
    s_mov_b64 exec, -1
fused_kernel_h337:
    s_cmp_lg_u32 s57, 0
    s_cbranch_scc1 fused_kernel_h038
    s_mov_b64 exec, 1
    s_lshl_b32 s50, s45, 21
    s_add_u32 s50, s50, 0x120000
    buffer_load_dword v17, v14, s[40:43], s50 offen sc1
    s_lshl_b32 s50, s2, 7
    s_mov_b64 exec, -1
fused_kernel_h038:
    s_barrier
    s_waitcnt vmcnt(0)
    s_barrier
    s_cmp_lg_u32 s57, 0
    s_cbranch_scc1 fused_kernel_h039
    s_cmp_lg_u32 s47, 0
    s_cbranch_scc1 fused_kernel_h039
    s_cmp_ge_u32 s46, 16
    s_cbranch_scc1 fused_kernel_h039
    s_lshl_b32 s50, s45, 4
    s_add_u32 s50, s50, s46
    v_mov_b32 v5, 1
    s_mov_b64 exec, 1
    buffer_store_byte v5, v14, s[36:39], s50 offen
    s_mov_b64 exec, -1
fused_kernel_h039:
    s_barrier
    s_barrier
    v_lshrrev_b32 v5, 3, v1
    v_mul_u32_u24 v5, 0xc00, v5
    v_and_b32 v6, 7, v1
    v_lshl_add_u32 v5, v6, 7, v5
    s_lshl_b32 s50, s46, 2
    s_add_u32 s50, s50, s57
    s_mul_i32 s50, s50, 12288
    s_mov_b32 exec_hi, 0
    buffer_load_dword v17, v5, s[8:11], s50 offen
    s_mov_b64 exec, -1
    s_cmp_lg_u32 s57, 0
    s_cbranch_scc1 fused_kernel_h040
    s_cmp_lg_u32 s47, 0
    s_cbranch_scc1 fused_kernel_fb41
    s_mov_b64 exec, 0xf
    s_lshl_b32 s50, s45, 4
    s_lshl_b32 s51, s55, 1
    v_subrev_u32 v6, s51, v1
    v_cmp_gt_u32 vcc, 2, v6
    v_mov_b32 v6, 0x80808080
    s_nop 0
    v_cndmask_b32 v15, 0, v6, vcc
    s_mov_b32 s53, 0
fused_kernel_p045:
    buffer_load_dword v160, v13, s[36:39], s50 offen sc1
    s_sleep 2
    buffer_load_dword v161, v13, s[36:39], s50 offen sc1
    s_sleep 2
    buffer_load_dword v162, v13, s[36:39], s50 offen sc1
fused_kernel_p42:
    s_waitcnt vmcnt(2)
    v_or_b32 v5, 0x80808080, v160
    v_subrev_u32 v5, 0x1010101, v5
    v_and_b32 v5, v5, v15
    v_cmp_ne_u32 vcc, v5, v15
    s_nop 4
    s_cbranch_vccz fused_kernel_x43
    buffer_load_dword v160, v13, s[36:39], s50 offen sc1
    s_waitcnt vmcnt(2)
    v_or_b32 v5, 0x80808080, v161
    v_subrev_u32 v5, 0x1010101, v5
    v_and_b32 v5, v5, v15
    v_cmp_ne_u32 vcc, v5, v15
    s_nop 4
    s_cbranch_vccz fused_kernel_x43
    buffer_load_dword v161, v13, s[36:39], s50 offen sc1
    s_waitcnt vmcnt(2)
    v_or_b32 v5, 0x80808080, v162
    v_subrev_u32 v5, 0x1010101, v5
    v_and_b32 v5, v5, v15
    v_cmp_ne_u32 vcc, v5, v15
    s_nop 4
    s_cbranch_vccz fused_kernel_x43
    buffer_load_dword v162, v13, s[36:39], s50 offen sc1
    s_add_u32 s53, s53, 1
    s_cmp_gt_u32 s53, 32768
    s_cbranch_scc1 fused_kernel_t44
    s_and_b32 s51, s53, 7
    s_cmp_lg_u32 s51, 0
    s_cbranch_scc1 fused_kernel_p42
    buffer_load_dword v6, v14, s[36:39], 0 offen offset:128 sc1
    s_waitcnt vmcnt(0)
    v_readfirstlane_b32 s51, v6
    s_nop 0
    s_lshr_b32 s51, s51, 16
    s_cmp_eq_u32 s51, 0
    s_cbranch_scc1 fused_kernel_p045
fused_kernel_t44:
    s_mov_b32 s48, 1
fused_kernel_x43:
    s_mov_b64 exec, -1
    s_branch fused_kernel_h040
fused_kernel_fb41:
    buffer_wbl2 sc1
    s_waitcnt vmcnt(0)
    s_mov_b64 exec, 1
    v_mov_b32 v5, 1
    buffer_atomic_add v5, v14, s[36:39], 0 offen offset:132 sc1
    s_mov_b32 s53, 0
fused_kernel_gp46:
    s_sleep 8
    s_add_u32 s53, s53, 1
    s_cmp_gt_u32 s53, 32768
    s_cbranch_scc1 fused_kernel_gx47
    buffer_load_dword v5, v14, s[36:39], 0 offen offset:132 sc1
    s_waitcnt vmcnt(0)
    v_cmp_gt_u32 vcc, 256, v5
    s_nop 4
    s_cbranch_vccnz fused_kernel_gp46
fused_kernel_gx47:
    s_mov_b64 exec, -1
    buffer_inv sc1
    s_waitcnt vmcnt(0)
    s_mov_b64 exec, -1
fused_kernel_h040:
    s_lshl_b32 s51, s47, 2
    s_add_u32 s51, s51, s57
    s_lshl_b32 s51, s51, 5
    s_add_u32 s51, s51, s46
    s_cmp_lg_u32 s51, 112
    s_cbranch_scc1 fused_kernel_ld48
    s_mov_b64 exec, 0xf
    s_lshl_b32 s50, s45, 4
    s_mov_b32 s51, 0x80808080
    v_mov_b32 v15, s51
    s_mov_b32 s53, 0
fused_kernel_p052:
    buffer_load_dword v160, v13, s[36:39], s50 offen sc1
    s_sleep 2
    buffer_load_dword v161, v13, s[36:39], s50 offen sc1
    s_sleep 2
    buffer_load_dword v162, v13, s[36:39], s50 offen sc1
fused_kernel_p49:
    s_waitcnt vmcnt(2)
    v_or_b32 v5, 0x80808080, v160
    v_subrev_u32 v5, 0x1010101, v5
    v_and_b32 v5, v5, v15
    v_cmp_ne_u32 vcc, v5, v15
    s_nop 4
    s_cbranch_vccz fused_kernel_x50
    buffer_load_dword v160, v13, s[36:39], s50 offen sc1
    s_waitcnt vmcnt(2)
    v_or_b32 v5, 0x80808080, v161
    v_subrev_u32 v5, 0x1010101, v5
    v_and_b32 v5, v5, v15
    v_cmp_ne_u32 vcc, v5, v15
    s_nop 4
    s_cbranch_vccz fused_kernel_x50
    buffer_load_dword v161, v13, s[36:39], s50 offen sc1
    s_waitcnt vmcnt(2)
    v_or_b32 v5, 0x80808080, v162
    v_subrev_u32 v5, 0x1010101, v5
    v_and_b32 v5, v5, v15
    v_cmp_ne_u32 vcc, v5, v15
    s_nop 4
    s_cbranch_vccz fused_kernel_x50
    buffer_load_dword v162, v13, s[36:39], s50 offen sc1
    s_add_u32 s53, s53, 1
    s_cmp_gt_u32 s53, 32768
    s_cbranch_scc1 fused_kernel_t51
    s_and_b32 s51, s53, 7
    s_cmp_lg_u32 s51, 0
    s_cbranch_scc1 fused_kernel_p49
    buffer_load_dword v6, v14, s[36:39], 0 offen offset:128 sc1
    s_waitcnt vmcnt(0)
    v_readfirstlane_b32 s51, v6
    s_nop 0
    s_lshr_b32 s51, s51, 16
    s_cmp_eq_u32 s51, 0
    s_cbranch_scc1 fused_kernel_p052
fused_kernel_t51:
    s_mov_b32 s48, 1
fused_kernel_x50:
    s_mov_b64 exec, 1
    v_mov_b32 v5, 1
    s_cmp_lg_u32 s48, 0
    s_mov_b32 s48, 0
    s_cbranch_scc1 fused_kernel_ld53
    buffer_atomic_add v5, v14, s[36:39], 0 offen offset:128 sc1
fused_kernel_ld53:
    s_mov_b64 exec, -1
fused_kernel_ld48:
    s_barrier
    s_barrier
    s_waitcnt vmcnt(0)
    s_add_u32 s52, s58, 0x0
    s_add_u32 m0, s60, 0x0
    s_nop 0
    buffer_load_dwordx4 v9, s[8:11], s52 offen lds
    s_add_u32 s52, s58, 0x30000
    s_add_u32 m0, s60, 0x1000
    s_nop 0
    buffer_load_dwordx4 v9, s[8:11], s52 offen lds
    s_add_u32 s52, s58, 0x60000
    s_add_u32 m0, s60, 0x2000
    s_nop 0
    buffer_load_dwordx4 v9, s[8:11], s52 offen lds
    s_add_u32 s52, s58, 0x90000
    s_add_u32 m0, s60, 0x3000
    s_nop 0
    buffer_load_dwordx4 v9, s[8:11], s52 offen lds
    s_add_u32 s52, s58, 0xc0000
    s_add_u32 m0, s60, 0x4000
    s_nop 0
    buffer_load_dwordx4 v9, s[8:11], s52 offen lds
    s_add_u32 s52, s58, 0xf0000
    s_add_u32 m0, s60, 0x5000
    s_nop 0
    buffer_load_dwordx4 v9, s[8:11], s52 offen lds
    s_add_u32 s52, s58, 0x120000
    s_add_u32 m0, s60, 0x6000
    s_nop 0
    buffer_load_dwordx4 v9, s[8:11], s52 offen lds
    s_add_u32 s52, s58, 0x150000
    s_add_u32 m0, s60, 0x7000
    s_nop 0
    buffer_load_dwordx4 v9, s[8:11], s52 offen lds
    s_and_b32 s50, s46, 31
    s_lshl_b32 s50, s50, 2
    s_add_u32 s50, s50, s57
    s_mul_i32 s50, s50, 2048
    s_mov_b32 exec_lo, 0xffff
    s_mov_b32 exec_hi, 0x0
    buffer_load_dword v17, v12, s[12:15], s50 offen
    s_mov_b64 exec, -1
    s_and_b32 s50, s46, 31
    s_lshl_b32 s50, s50, 2
    s_add_u32 s50, s50, s57
    s_mul_i32 s50, s50, 2048
    s_add_u32 s50, s50, 0x40000
    s_mov_b32 exec_lo, 0xffff
    s_mov_b32 exec_hi, 0x0
    buffer_load_dword v17, v12, s[12:15], s50 offen
    s_mov_b64 exec, -1
    s_and_b32 s50, s46, 31
    s_lshl_b32 s50, s50, 2
    s_add_u32 s50, s50, s57
    s_mul_i32 s50, s50, 2048
    s_mov_b32 exec_lo, 0xffff
    s_mov_b32 exec_hi, 0x0
    buffer_load_dword v17, v12, s[16:19], s50 offen
    s_mov_b64 exec, -1
    s_barrier
    s_waitcnt vmcnt(3)
    s_barrier
    s_cmp_lg_u32 s57, 0
    s_cbranch_scc1 fused_kernel_h054
    s_cmp_lg_u32 s47, 0
    s_cbranch_scc1 fused_kernel_rx55
    s_mov_b64 exec, 1
    s_mov_b32 s53, 0
fused_kernel_rp56:
    buffer_load_dword v16, v14, s[36:39], 0 offen offset:128 sc1
    s_waitcnt vmcnt(0)
    v_readfirstlane_b32 s51, v16
    s_nop 0
    s_lshr_b32 s50, s51, 16
    s_cmp_lg_u32 s50, 0
    s_cbranch_scc1 fused_kernel_rt57
    s_cmp_eq_u32 s51, 8
    s_cbranch_scc1 fused_kernel_rx55
    s_add_u32 s53, s53, 1
    s_cmp_gt_u32 s53, 32768
    s_cbranch_scc1 fused_kernel_rt57
    s_sleep 4
    s_branch fused_kernel_rp56
fused_kernel_rt57:
    s_mov_b32 s48, 1
fused_kernel_rx55:
    s_mov_b64 exec, -1
fused_kernel_h054:
    s_cmp_lg_u32 s57, 2
    s_cbranch_scc1 fused_kernel_h258
    s_and_b32 s50, s46, 31
    s_mul_i32 s50, s50, 1280
    v_add_u32 v5, s50, v12
    s_mov_b64 exec, 0x3ff
    buffer_load_dword v17, v5, s[76:79], 0 offen
    s_mov_b64 exec, -1
fused_kernel_h258:
    s_lshl_b32 s50, s45, 21
    s_lshr_b32 s51, s46, 4
    s_mul_i32 s51, s51, 458752
    s_add_u32 s50, s50, s51
    s_and_b32 s51, s46, 15
    s_lshl_b32 s51, s51, 2
    s_add_u32 s51, s51, s57
    s_mul_i32 s51, s51, 2048
    s_add_u32 s50, s50, 0x40000
    s_add_u32 s50, s50, s51
    s_mov_b32 exec_lo, 0xffff
    s_mov_b32 exec_hi, 0x0
    buffer_load_dword v17, v12, s[40:43], s50 offen sc1
    s_mov_b64 exec, -1
    s_and_b32 s50, s46, 31
    s_lshl_b32 s50, s50, 2
    s_add_u32 s50, s50, s57
    s_mul_i32 s50, s50, 2048
    s_add_u32 s50, s50, 0x40000
    s_mov_b32 exec_lo, 0xffff
    s_mov_b32 exec_hi, 0x0
    buffer_load_dword v17, v12, s[16:19], s50 offen
    s_mov_b64 exec, -1
    s_and_b32 s50, s46, 31
    s_lshl_b32 s50, s50, 2
    s_add_u32 s50, s50, s57
    s_mul_i32 s50, s50, 2048
    s_add_u32 s50, s50, 0x80000
    s_mov_b32 exec_lo, 0xffff
    s_mov_b32 exec_hi, 0x0
    buffer_load_dword v17, v12, s[16:19], s50 offen
    s_mov_b64 exec, -1
    s_cmp_lg_u32 s57, 0
    s_cbranch_scc1 fused_kernel_h059
    s_mov_b64 exec, 1
    v_mov_b32 v5, s48
    v_mov_b32 v6, 61440
    ds_write_b32 v6, v5
    s_waitcnt lgkmcnt(0)
    s_mov_b64 exec, -1
fused_kernel_h059:
    s_barrier
    s_cmp_lg_u32 s57, 0
    s_cbranch_scc1 fused_kernel_h060
    s_cmp_lg_u32 s47, 0
    s_cbranch_scc1 fused_kernel_fb61
    s_mov_b64 exec, -1
    s_branch fused_kernel_h060
fused_kernel_fb61:
    buffer_wbl2 sc1
    s_waitcnt vmcnt(0)
    s_mov_b64 exec, 1
    v_mov_b32 v5, 1
    buffer_atomic_add v5, v14, s[36:39], 0 offen offset:136 sc1
    s_mov_b32 s53, 0
fused_kernel_gp62:
    s_sleep 8
    s_add_u32 s53, s53, 1
    s_cmp_gt_u32 s53, 32768
    s_cbranch_scc1 fused_kernel_gx63
    buffer_load_dword v5, v14, s[36:39], 0 offen offset:136 sc1
    s_waitcnt vmcnt(0)
    v_cmp_gt_u32 vcc, 256, v5
    s_nop 4
    s_cbranch_vccnz fused_kernel_gp62
fused_kernel_gx63:
    s_mov_b64 exec, -1
    buffer_inv sc1
    s_waitcnt vmcnt(0)
    s_mov_b64 exec, -1
fused_kernel_h060:
    s_barrier
    v_mov_b32 v6, 61440
    ds_read_b32 v8, v6
    s_waitcnt lgkmcnt(0)
    v_readfirstlane_b32 s51, v8
    s_nop 0
    s_cmp_lg_u32 s51, 0
    s_cbranch_scc1 fused_kernel_hfallback
    s_waitcnt vmcnt(0)
    s_add_u32 s52, s61, 0x0
    s_add_u32 m0, s60, 0x18000
    s_nop 0
    buffer_load_dwordx4 v10, s[12:15], s52 offen lds
    s_add_u32 s52, s61, 0x40000
    s_add_u32 m0, s60, 0x19000
    s_nop 0
    buffer_load_dwordx4 v10, s[12:15], s52 offen lds
    s_add_u32 s52, s61, 0x8000
    s_add_u32 m0, s60, 0x1a000
    s_nop 0
    buffer_load_dwordx4 v10, s[12:15], s52 offen lds
    s_add_u32 s52, s61, 0x48000
    s_add_u32 m0, s60, 0x1b000
    s_nop 0
    buffer_load_dwordx4 v10, s[12:15], s52 offen lds
    s_add_u32 s52, s61, 0x10000
    s_add_u32 m0, s60, 0x1c000
    s_nop 0
    buffer_load_dwordx4 v10, s[12:15], s52 offen lds
    s_add_u32 s52, s61, 0x50000
    s_add_u32 m0, s60, 0x1d000
    s_nop 0
    buffer_load_dwordx4 v10, s[12:15], s52 offen lds
    s_add_u32 s52, s61, 0x18000
    s_add_u32 m0, s60, 0x1e000
    s_nop 0
    buffer_load_dwordx4 v10, s[12:15], s52 offen lds
    s_add_u32 s52, s61, 0x58000
    s_add_u32 m0, s60, 0x1f000
    s_nop 0
    buffer_load_dwordx4 v10, s[12:15], s52 offen lds
    s_add_u32 s52, s61, 0x20000
    s_add_u32 m0, s60, 0x20000
    s_nop 0
    buffer_load_dwordx4 v10, s[12:15], s52 offen lds
    s_add_u32 s52, s61, 0x60000
    s_add_u32 m0, s60, 0x21000
    s_nop 0
    buffer_load_dwordx4 v10, s[12:15], s52 offen lds
    s_add_u32 s52, s61, 0x28000
    s_add_u32 m0, s60, 0x22000
    s_nop 0
    buffer_load_dwordx4 v10, s[12:15], s52 offen lds
    s_add_u32 s52, s61, 0x68000
    s_add_u32 m0, s60, 0x23000
    s_nop 0
    buffer_load_dwordx4 v10, s[12:15], s52 offen lds
    s_add_u32 s52, s61, 0x30000
    s_add_u32 m0, s60, 0x24000
    s_nop 0
    buffer_load_dwordx4 v10, s[12:15], s52 offen lds
    s_add_u32 s52, s61, 0x70000
    s_add_u32 m0, s60, 0x25000
    s_nop 0
    buffer_load_dwordx4 v10, s[12:15], s52 offen lds
    s_add_u32 s52, s61, 0x38000
    s_add_u32 m0, s60, 0x26000
    s_nop 0
    buffer_load_dwordx4 v10, s[12:15], s52 offen lds
    s_add_u32 s52, s61, 0x78000
    s_add_u32 m0, s60, 0x27000
    s_nop 0
    buffer_load_dwordx4 v10, s[12:15], s52 offen lds
    s_barrier
    s_add_u32 m0, s60, 0x10000
    s_mov_b32 s52, 0x0
    buffer_load_dwordx4 v11, s[16:19], s52 offen lds
    s_add_u32 m0, s60, 0x11000
    s_mov_b32 s52, 0xe000
    buffer_load_dwordx4 v11, s[16:19], s52 offen lds
    s_add_u32 m0, s60, 0x12000
    s_mov_b32 s52, 0x1c000
    buffer_load_dwordx4 v11, s[16:19], s52 offen lds
    s_add_u32 m0, s60, 0x13000
    s_mov_b32 s52, 0x2a000
    buffer_load_dwordx4 v11, s[16:19], s52 offen lds
    s_add_u32 m0, s60, 0x14000
    s_mov_b32 s52, 0x38000
    buffer_load_dwordx4 v11, s[16:19], s52 offen lds
    s_add_u32 m0, s60, 0x15000
    s_mov_b32 s52, 0x46000
    buffer_load_dwordx4 v11, s[16:19], s52 offen lds
    s_add_u32 m0, s60, 0x16000
    s_mov_b32 s52, 0x54000
    buffer_load_dwordx4 v11, s[16:19], s52 offen lds
    s_add_u32 m0, s60, 0x17000
    s_mov_b32 s52, 0x62000
    buffer_load_dwordx4 v11, s[16:19], s52 offen lds
    s_waitcnt vmcnt(0)
    s_barrier
    s_cmp_lg_u32 s57, 0
    s_cbranch_scc1 fused_kernel_h064
    s_cmp_lg_u32 s47, 0
    s_cbranch_scc1 fused_kernel_h064
    s_lshl_b32 s50, s45, 21
    s_add_u32 s50, s50, 0x120000
    s_add_u32 s50, s50, s46
    v_mov_b32 v5, 1
    s_mov_b64 exec, 1
    buffer_store_byte v5, v14, s[40:43], s50 offen
    s_mov_b64 exec, -1
    s_mov_b64 exec, -1
fused_kernel_h064:
    s_cmp_eq_u32 s57, 0
    s_cbranch_scc1 fused_kernel_xs66
    s_sleep 2
fused_kernel_xs66:
    s_lshl_b32 s50, s45, 21
    s_lshl_b32 s51, s46, 13
    s_add_u32 s50, s50, s51
    s_lshl_b32 s51, s57, 11
    s_add_u32 s50, s50, s51
    s_mov_b32 exec_lo, 0xffff
    s_mov_b32 exec_hi, 0x0
    buffer_load_dword v17, v12, s[40:43], s50 offen sc1
    s_mov_b64 exec, -1
    s_cmp_lg_u32 s57, 2
    s_cbranch_scc1 fused_kernel_h267
    s_and_b32 s50, s46, 31
    s_mul_i32 s50, s50, 1280
    v_add_u32 v5, s50, v12
    s_mov_b64 exec, 0x3ff
    buffer_load_dword v17, v5, s[76:79], 0 offen
    s_mov_b64 exec, -1
fused_kernel_h267:
    s_and_b32 s50, s46, 31
    s_lshl_b32 s50, s50, 2
    s_add_u32 s50, s50, s57
    s_mul_i32 s50, s50, 2048
    s_add_u32 s50, s50, 0xc0000
    s_mov_b32 exec_lo, 0xffff
    s_mov_b32 exec_hi, 0x0
    buffer_load_dword v17, v12, s[16:19], s50 offen
    s_mov_b64 exec, -1
    s_and_b32 s50, s46, 31
    s_lshl_b32 s50, s50, 2
    s_add_u32 s50, s50, s57
    s_mul_i32 s50, s50, 2048
    s_add_u32 s50, s50, 0x100000
    s_mov_b32 exec_lo, 0xffff
    s_mov_b32 exec_hi, 0x0
    buffer_load_dword v17, v12, s[16:19], s50 offen
    s_mov_b64 exec, -1
    s_cmp_lg_u32 s57, 0
    s_cbranch_scc1 fused_kernel_h068
    s_cmp_lg_u32 s47, 0
    s_cbranch_scc1 fused_kernel_fb69
    s_mov_b64 exec, 0xff
    s_lshl_b32 s50, s45, 21
    s_add_u32 s50, s50, 0x120000
    s_bfe_u32 s51, s46, 0x10001
    s_lshl_b32 s51, s51, 3
    s_lshl_b32 s51, 0x00800080, s51
    v_mov_b32 v15, s51
    s_mov_b32 s53, 0
fused_kernel_p073:
    buffer_load_dword v160, v13, s[40:43], s50 offen sc1
    s_sleep 2
    buffer_load_dword v161, v13, s[40:43], s50 offen sc1
    s_sleep 2
    buffer_load_dword v162, v13, s[40:43], s50 offen sc1
fused_kernel_p70:
    s_waitcnt vmcnt(2)
    v_or_b32 v5, 0x80808080, v160
    v_subrev_u32 v5, 0x1010101, v5
    v_and_b32 v5, v5, v15
    v_cmp_ne_u32 vcc, v5, v15
    s_nop 4
    s_cbranch_vccz fused_kernel_x71
    buffer_load_dword v160, v13, s[40:43], s50 offen sc1
    s_waitcnt vmcnt(2)
    v_or_b32 v5, 0x80808080, v161
    v_subrev_u32 v5, 0x1010101, v5
    v_and_b32 v5, v5, v15
    v_cmp_ne_u32 vcc, v5, v15
    s_nop 4
    s_cbranch_vccz fused_kernel_x71
    buffer_load_dword v161, v13, s[40:43], s50 offen sc1
    s_waitcnt vmcnt(2)
    v_or_b32 v5, 0x80808080, v162
    v_subrev_u32 v5, 0x1010101, v5
    v_and_b32 v5, v5, v15
    v_cmp_ne_u32 vcc, v5, v15
    s_nop 4
    s_cbranch_vccz fused_kernel_x71
    buffer_load_dword v162, v13, s[40:43], s50 offen sc1
    s_add_u32 s53, s53, 1
    s_cmp_gt_u32 s53, 32768
    s_cbranch_scc1 fused_kernel_t72
    s_branch fused_kernel_p70
fused_kernel_t72:
    s_mov_b32 s48, 1
fused_kernel_x71:
    s_mov_b64 exec, -1
    s_branch fused_kernel_h068
fused_kernel_fb69:
    buffer_wbl2 sc1
    s_waitcnt vmcnt(0)
    s_mov_b64 exec, 1
    v_mov_b32 v5, 1
    buffer_atomic_add v5, v14, s[36:39], 0 offen offset:140 sc1
    s_mov_b32 s53, 0
fused_kernel_gp74:
    s_sleep 8
    s_add_u32 s53, s53, 1
    s_cmp_gt_u32 s53, 32768
    s_cbranch_scc1 fused_kernel_gx75
    buffer_load_dword v5, v14, s[36:39], 0 offen offset:140 sc1
    s_waitcnt vmcnt(0)
    v_cmp_gt_u32 vcc, 256, v5
    s_nop 4
    s_cbranch_vccnz fused_kernel_gp74
fused_kernel_gx75:
    s_mov_b64 exec, -1
    buffer_inv sc1
    s_waitcnt vmcnt(0)
    s_mov_b64 exec, -1
fused_kernel_h068:
    s_barrier
    s_barrier
    s_add_u32 m0, s60, 0x8000
    s_mov_b32 s52, 0x70000
    buffer_load_dwordx4 v11, s[16:19], s52 offen lds
    s_add_u32 m0, s60, 0x9000
    s_mov_b32 s52, 0x7e000
    buffer_load_dwordx4 v11, s[16:19], s52 offen lds
    s_add_u32 m0, s60, 0xa000
    s_mov_b32 s52, 0x8c000
    buffer_load_dwordx4 v11, s[16:19], s52 offen lds
    s_add_u32 m0, s60, 0xb000
    s_mov_b32 s52, 0x9a000
    buffer_load_dwordx4 v11, s[16:19], s52 offen lds
    s_add_u32 m0, s60, 0xc000
    s_mov_b32 s52, 0xa8000
    buffer_load_dwordx4 v11, s[16:19], s52 offen lds
    s_add_u32 m0, s60, 0xd000
    s_mov_b32 s52, 0xb6000
    buffer_load_dwordx4 v11, s[16:19], s52 offen lds
    s_add_u32 m0, s60, 0x0
    s_mov_b32 s52, 0xc4000
    buffer_load_dwordx4 v11, s[16:19], s52 offen lds
    s_add_u32 m0, s60, 0x1000
    s_mov_b32 s52, 0xd2000
    buffer_load_dwordx4 v11, s[16:19], s52 offen lds
    s_add_u32 m0, s60, 0x2000
    s_mov_b32 s52, 0xe0000
    buffer_load_dwordx4 v11, s[16:19], s52 offen lds
    s_add_u32 m0, s60, 0x3000
    s_mov_b32 s52, 0xee000
    buffer_load_dwordx4 v11, s[16:19], s52 offen lds
    s_add_u32 m0, s60, 0x4000
    s_mov_b32 s52, 0xfc000
    buffer_load_dwordx4 v11, s[16:19], s52 offen lds
    s_add_u32 m0, s60, 0x5000
    s_mov_b32 s52, 0x10a000
    buffer_load_dwordx4 v11, s[16:19], s52 offen lds
    s_and_b32 s50, s46, 31
    s_lshl_b32 s50, s50, 2
    s_add_u32 s50, s50, s57
    s_mul_i32 s50, s50, 2048
    s_add_u32 s50, s50, 0x140000
    s_mov_b32 exec_lo, 0xffff
    s_mov_b32 exec_hi, 0x0
    buffer_load_dword v17, v12, s[16:19], s50 offen
    s_mov_b64 exec, -1
    s_and_b32 s50, s46, 31
    s_lshl_b32 s50, s50, 2
    s_add_u32 s50, s50, s57
    s_mul_i32 s50, s50, 2048
    s_add_u32 s50, s50, 0x180000
    s_mov_b32 exec_lo, 0xffff
    s_mov_b32 exec_hi, 0x0
    buffer_load_dword v17, v12, s[16:19], s50 offen
    s_mov_b64 exec, -1
    s_barrier
    s_waitcnt vmcnt(2)
    s_barrier
    s_cmp_ge_u32 s46, 16
    s_cbranch_scc1 fused_kernel_hfree76
    s_cmp_lg_u32 s57, 0
    s_cbranch_scc1 fused_kernel_h078
    s_cmp_lg_u32 s47, 0
    s_cbranch_scc1 fused_kernel_fb79
    s_lshl_b32 s50, s45, 21
    s_add_u32 s50, s50, 0x120000
    s_add_u32 s50, s50, s46
    v_mov_b32 v5, 2
    s_mov_b64 exec, 1
    buffer_store_byte v5, v14, s[40:43], s50 offen
    s_mov_b64 exec, 0xff
    s_lshl_b32 s50, s45, 21
    s_add_u32 s50, s50, 0x120000
    s_lshr_b32 s51, s46, 2
    s_lshl_b32 s51, s51, 3
    s_lshl_b32 s51, 0x80, s51
    v_mov_b32 v15, s51
    s_mov_b32 s53, 0
fused_kernel_p083:
    buffer_load_dword v160, v13, s[40:43], s50 offen sc1
    s_sleep 2
    buffer_load_dword v161, v13, s[40:43], s50 offen sc1
    s_sleep 2
    buffer_load_dword v162, v13, s[40:43], s50 offen sc1
fused_kernel_p80:
    s_waitcnt vmcnt(2)
    v_or_b32 v5, 0x80808080, v160
    v_subrev_u32 v5, 0x2020202, v5
    v_and_b32 v5, v5, v15
    v_cmp_ne_u32 vcc, v5, v15
    s_nop 4
    s_cbranch_vccz fused_kernel_x81
    buffer_load_dword v160, v13, s[40:43], s50 offen sc1
    s_waitcnt vmcnt(2)
    v_or_b32 v5, 0x80808080, v161
    v_subrev_u32 v5, 0x2020202, v5
    v_and_b32 v5, v5, v15
    v_cmp_ne_u32 vcc, v5, v15
    s_nop 4
    s_cbranch_vccz fused_kernel_x81
    buffer_load_dword v161, v13, s[40:43], s50 offen sc1
    s_waitcnt vmcnt(2)
    v_or_b32 v5, 0x80808080, v162
    v_subrev_u32 v5, 0x2020202, v5
    v_and_b32 v5, v5, v15
    v_cmp_ne_u32 vcc, v5, v15
    s_nop 4
    s_cbranch_vccz fused_kernel_x81
    buffer_load_dword v162, v13, s[40:43], s50 offen sc1
    s_add_u32 s53, s53, 1
    s_cmp_gt_u32 s53, 32768
    s_cbranch_scc1 fused_kernel_t82
    s_branch fused_kernel_p80
fused_kernel_t82:
    s_mov_b32 s48, 1
fused_kernel_x81:
    s_mov_b64 exec, -1
    s_branch fused_kernel_h078
fused_kernel_fb79:
    buffer_wbl2 sc1
    s_waitcnt vmcnt(0)
    s_mov_b64 exec, 1
    v_mov_b32 v5, 1
    buffer_atomic_add v5, v14, s[36:39], 0 offen offset:144 sc1
    s_mov_b32 s53, 0
fused_kernel_gp84:
    s_sleep 8
    s_add_u32 s53, s53, 1
    s_cmp_gt_u32 s53, 32768
    s_cbranch_scc1 fused_kernel_gx85
    buffer_load_dword v5, v14, s[36:39], 0 offen offset:144 sc1
    s_waitcnt vmcnt(0)
    v_cmp_gt_u32 vcc, 256, v5
    s_nop 4
    s_cbranch_vccnz fused_kernel_gp84
fused_kernel_gx85:
    s_mov_b64 exec, -1
    buffer_inv sc1
    s_waitcnt vmcnt(0)
    s_mov_b64 exec, -1
fused_kernel_h078:
    s_barrier
    s_barrier
    s_add_u32 m0, s60, 0x6000
    s_mov_b32 s52, 0x118000
    buffer_load_dwordx4 v11, s[16:19], s52 offen lds
    s_add_u32 m0, s60, 0x7000
    s_mov_b32 s52, 0x126000
    buffer_load_dwordx4 v11, s[16:19], s52 offen lds
    s_add_u32 m0, s60, 0xe000
    s_mov_b32 s52, 0x134000
    buffer_load_dwordx4 v11, s[16:19], s52 offen lds
    s_add_u32 m0, s60, 0xf000
    s_mov_b32 s52, 0x142000
    buffer_load_dwordx4 v11, s[16:19], s52 offen lds
    s_add_u32 m0, s60, 0x20000
    s_mov_b32 s52, 0x150000
    buffer_load_dwordx4 v11, s[16:19], s52 offen lds
    s_add_u32 m0, s60, 0x21000
    s_mov_b32 s52, 0x15e000
    buffer_load_dwordx4 v11, s[16:19], s52 offen lds
    s_add_u32 m0, s60, 0x22000
    s_mov_b32 s52, 0x16c000
    buffer_load_dwordx4 v11, s[16:19], s52 offen lds
    s_add_u32 m0, s60, 0x23000
    s_mov_b32 s52, 0x17a000
    buffer_load_dwordx4 v11, s[16:19], s52 offen lds
    s_add_u32 m0, s60, 0x24000
    s_mov_b32 s52, 0x188000
    buffer_load_dwordx4 v11, s[16:19], s52 offen lds
    s_add_u32 m0, s60, 0x25000
    s_mov_b32 s52, 0x196000
    buffer_load_dwordx4 v11, s[16:19], s52 offen lds
    s_add_u32 m0, s60, 0x26000
    s_mov_b32 s52, 0x1a4000
    buffer_load_dwordx4 v11, s[16:19], s52 offen lds
    s_add_u32 m0, s60, 0x27000
    s_mov_b32 s52, 0x1b2000
    buffer_load_dwordx4 v11, s[16:19], s52 offen lds
    s_barrier
    s_waitcnt vmcnt(0)
    s_branch fused_kernel_hjoin77
fused_kernel_hfree76:
    s_cmp_lg_u32 s57, 0
    s_cbranch_scc1 fused_kernel_h086
    s_cmp_lg_u32 s47, 0
    s_cbranch_scc1 fused_kernel_fb87
    s_lshl_b32 s50, s45, 21
    s_add_u32 s50, s50, 0x120000
    s_add_u32 s50, s50, s46
    v_mov_b32 v5, 2
    s_mov_b64 exec, 1
    buffer_store_byte v5, v14, s[40:43], s50 offen
    s_mov_b64 exec, -1
    s_branch fused_kernel_h086
fused_kernel_fb87:
    buffer_wbl2 sc1
    s_waitcnt vmcnt(0)
    s_mov_b64 exec, 1
    v_mov_b32 v5, 1
    buffer_atomic_add v5, v14, s[36:39], 0 offen offset:144 sc1
    s_mov_b32 s53, 0
fused_kernel_gp88:
    s_sleep 8
    s_add_u32 s53, s53, 1
    s_cmp_gt_u32 s53, 32768
    s_cbranch_scc1 fused_kernel_gx89
    buffer_load_dword v5, v14, s[36:39], 0 offen offset:144 sc1
    s_waitcnt vmcnt(0)
    v_cmp_gt_u32 vcc, 256, v5
    s_nop 4
    s_cbranch_vccnz fused_kernel_gp88
fused_kernel_gx89:
    s_mov_b64 exec, -1
    buffer_inv sc1
    s_waitcnt vmcnt(0)
    s_mov_b64 exec, -1
fused_kernel_h086:
    s_add_u32 m0, s60, 0x6000
    s_mov_b32 s52, 0x118000
    buffer_load_dwordx4 v11, s[16:19], s52 offen lds
    s_add_u32 m0, s60, 0x7000
    s_mov_b32 s52, 0x126000
    buffer_load_dwordx4 v11, s[16:19], s52 offen lds
    s_add_u32 m0, s60, 0xe000
    s_mov_b32 s52, 0x134000
    buffer_load_dwordx4 v11, s[16:19], s52 offen lds
    s_add_u32 m0, s60, 0xf000
    s_mov_b32 s52, 0x142000
    buffer_load_dwordx4 v11, s[16:19], s52 offen lds
    s_add_u32 m0, s60, 0x20000
    s_mov_b32 s52, 0x150000
    buffer_load_dwordx4 v11, s[16:19], s52 offen lds
    s_add_u32 m0, s60, 0x21000
    s_mov_b32 s52, 0x15e000
    buffer_load_dwordx4 v11, s[16:19], s52 offen lds
    s_add_u32 m0, s60, 0x22000
    s_mov_b32 s52, 0x16c000
    buffer_load_dwordx4 v11, s[16:19], s52 offen lds
    s_add_u32 m0, s60, 0x23000
    s_mov_b32 s52, 0x17a000
    buffer_load_dwordx4 v11, s[16:19], s52 offen lds
    s_add_u32 m0, s60, 0x24000
    s_mov_b32 s52, 0x188000
    buffer_load_dwordx4 v11, s[16:19], s52 offen lds
    s_add_u32 m0, s60, 0x25000
    s_mov_b32 s52, 0x196000
    buffer_load_dwordx4 v11, s[16:19], s52 offen lds
    s_add_u32 m0, s60, 0x26000
    s_mov_b32 s52, 0x1a4000
    buffer_load_dwordx4 v11, s[16:19], s52 offen lds
    s_add_u32 m0, s60, 0x27000
    s_mov_b32 s52, 0x1b2000
    buffer_load_dwordx4 v11, s[16:19], s52 offen lds
    s_cmp_lg_u32 s57, 2
    s_cbranch_scc1 fused_kernel_h290
    s_and_b32 s50, s46, 15
    s_mul_i32 s50, s50, 2560
    v_add_u32 v5, s50, v12
    s_mov_b64 exec, 0xfffff
    buffer_load_dword v17, v5, s[76:79], 0 offen
    s_mov_b64 exec, -1
fused_kernel_h290:
    s_and_b32 s50, s46, 15
    s_lshl_b32 s50, s50, 2
    s_add_u32 s50, s50, s57
    s_mul_i32 s50, s50, 4096
    s_mov_b32 exec_lo, 0xffffffff
    s_mov_b32 exec_hi, 0x0
    buffer_load_dword v17, v12, s[24:27], s50 offen
    s_mov_b64 exec, -1
    s_and_b32 s50, s46, 15
    s_lshl_b32 s50, s50, 2
    s_add_u32 s50, s50, s57
    s_mul_i32 s50, s50, 4096
    s_add_u32 s50, s50, 0xc0000
    s_mov_b32 exec_lo, 0xffffffff
    s_mov_b32 exec_hi, 0x0
    buffer_load_dword v17, v12, s[24:27], s50 offen
    s_mov_b64 exec, -1
    s_and_b32 s50, s46, 15
    s_lshl_b32 s50, s50, 2
    s_add_u32 s50, s50, s57
    s_mul_i32 s50, s50, 4096
    s_add_u32 s50, s50, 0x100000
    s_mov_b32 exec_lo, 0xffffffff
    s_mov_b32 exec_hi, 0x0
    buffer_load_dword v17, v12, s[24:27], s50 offen
    s_mov_b64 exec, -1
    s_and_b32 s50, s46, 15
    s_lshl_b32 s50, s50, 2
    s_add_u32 s50, s50, s57
    s_mul_i32 s50, s50, 4096
    s_add_u32 s50, s50, 0x140000
    s_mov_b32 exec_lo, 0xffffffff
    s_mov_b32 exec_hi, 0x0
    buffer_load_dword v17, v12, s[24:27], s50 offen
    s_mov_b64 exec, -1
    s_and_b32 s50, s46, 15
    s_lshl_b32 s50, s50, 2
    s_add_u32 s50, s50, s57
    s_mul_i32 s50, s50, 2048
    s_add_u32 s50, s50, 0x40000
    s_mov_b32 exec_lo, 0xffff
    s_mov_b32 exec_hi, 0x0
    buffer_load_dword v17, v12, s[24:27], s50 offen
    s_mov_b64 exec, -1
    s_waitcnt vmcnt(5)
fused_kernel_hjoin77:
    s_barrier
    s_cmp_lg_u32 s57, 0
    s_cbranch_scc1 fused_kernel_h091
    s_cmp_lg_u32 s47, 0
    s_cbranch_scc1 fused_kernel_fb92
    s_lshl_b32 s50, s45, 21
    s_add_u32 s50, s50, 0x120000
    s_add_u32 s50, s50, s46
    v_mov_b32 v5, 3
    s_mov_b64 exec, 1
    buffer_store_byte v5, v14, s[40:43], s50 offen
    s_mov_b64 exec, 0xff
    s_lshl_b32 s50, s45, 21
    s_add_u32 s50, s50, 0x120000
    s_lshl_b32 s51, s55, 1
    v_subrev_u32 v6, s51, v1
    v_cmp_gt_u32 vcc, 2, v6
    v_mov_b32 v6, 0x80808080
    s_nop 0
    v_cndmask_b32 v15, 0, v6, vcc
    s_mov_b32 s53, 0
fused_kernel_p096:
    buffer_load_dword v160, v13, s[40:43], s50 offen sc1
    s_sleep 2
    buffer_load_dword v161, v13, s[40:43], s50 offen sc1
    s_sleep 2
    buffer_load_dword v162, v13, s[40:43], s50 offen sc1
fused_kernel_p93:
    s_waitcnt vmcnt(2)
    v_or_b32 v5, 0x80808080, v160
    v_subrev_u32 v5, 0x3030303, v5
    v_and_b32 v5, v5, v15
    v_cmp_ne_u32 vcc, v5, v15
    s_nop 4
    s_cbranch_vccz fused_kernel_x94
    buffer_load_dword v160, v13, s[40:43], s50 offen sc1
    s_waitcnt vmcnt(2)
    v_or_b32 v5, 0x80808080, v161
    v_subrev_u32 v5, 0x3030303, v5
    v_and_b32 v5, v5, v15
    v_cmp_ne_u32 vcc, v5, v15
    s_nop 4
    s_cbranch_vccz fused_kernel_x94
    buffer_load_dword v161, v13, s[40:43], s50 offen sc1
    s_waitcnt vmcnt(2)
    v_or_b32 v5, 0x80808080, v162
    v_subrev_u32 v5, 0x3030303, v5
    v_and_b32 v5, v5, v15
    v_cmp_ne_u32 vcc, v5, v15
    s_nop 4
    s_cbranch_vccz fused_kernel_x94
    buffer_load_dword v162, v13, s[40:43], s50 offen sc1
    s_add_u32 s53, s53, 1
    s_cmp_gt_u32 s53, 32768
    s_cbranch_scc1 fused_kernel_t95
    s_branch fused_kernel_p93
fused_kernel_t95:
    s_mov_b32 s48, 1
fused_kernel_x94:
    s_mov_b64 exec, -1
    s_branch fused_kernel_h091
fused_kernel_fb92:
    buffer_wbl2 sc1
    s_waitcnt vmcnt(0)
    s_mov_b64 exec, 1
    v_mov_b32 v5, 1
    buffer_atomic_add v5, v14, s[36:39], 0 offen offset:148 sc1
    s_mov_b32 s53, 0
fused_kernel_gp97:
    s_sleep 8
    s_add_u32 s53, s53, 1
    s_cmp_gt_u32 s53, 32768
    s_cbranch_scc1 fused_kernel_gx98
    buffer_load_dword v5, v14, s[36:39], 0 offen offset:148 sc1
    s_waitcnt vmcnt(0)
    v_cmp_gt_u32 vcc, 256, v5
    s_nop 4
    s_cbranch_vccnz fused_kernel_gp97
fused_kernel_gx98:
    s_mov_b64 exec, -1
    buffer_inv sc1
    s_waitcnt vmcnt(0)
    s_mov_b64 exec, -1
fused_kernel_h091:
    s_barrier
    s_barrier
    s_cmp_lg_u32 s57, 2
    s_cbranch_scc1 fused_kernel_h299
    s_and_b32 s50, s46, 31
    s_mul_i32 s50, s50, 1280
    v_add_u32 v5, s50, v12
    s_mov_b64 exec, 0x3ff
    buffer_load_dword v17, v5, s[76:79], 0 offen
    s_mov_b64 exec, -1
fused_kernel_h299:
    s_lshl_b32 s50, s45, 21
    s_lshr_b32 s51, s46, 1
    s_mul_i32 s51, s51, 57344
    s_add_u32 s50, s50, s51
    s_lshl_b32 s51, s55, 2
    s_add_u32 s51, s51, s57
    s_mul_i32 s51, s51, 7168
    s_add_u32 s50, s50, s51
    s_add_u32 s50, s50, 0x40c00
    v_lshrrev_b32 v5, 3, v1
    v_mul_u32_u24 v5, 2048, v5
    v_add_u32 v5, v5, v12
    s_mov_b64 exec, 0xffff
    buffer_load_dword v17, v5, s[40:43], s50 offen sc1
    s_mov_b64 exec, -1
    s_and_b32 s50, s46, 31
    s_lshl_b32 s50, s50, 2
    s_add_u32 s50, s50, s57
    s_mul_i32 s50, s50, 2048
    s_add_u32 s50, s50, 0x80000
    s_mov_b32 exec_lo, 0xffff
    s_mov_b32 exec_hi, 0x0
    buffer_load_dword v17, v12, s[24:27], s50 offen
    s_mov_b64 exec, -1
    s_and_b32 s50, s46, 31
    s_lshl_b32 s50, s50, 2
    s_add_u32 s50, s50, s57
    s_mul_i32 s50, s50, 1024
    s_add_u32 s50, s50, 0x60000
    s_mov_b32 exec_lo, 0xff
    s_mov_b32 exec_hi, 0x0
    buffer_load_dword v17, v12, s[24:27], s50 offen
    s_mov_b64 exec, -1
    s_add_u32 s52, s61, 0xc0000
    buffer_load_dwordx4 v[24:27], v10, s[24:27], s52 offen
    s_add_u32 s52, s61, 0xd0000
    buffer_load_dwordx4 v[28:31], v10, s[24:27], s52 offen
    s_add_u32 s52, s61, 0xe0000
    buffer_load_dwordx4 v[32:35], v10, s[24:27], s52 offen
    s_add_u32 s52, s61, 0xf0000
    buffer_load_dwordx4 v[36:39], v10, s[24:27], s52 offen
    s_add_u32 s52, s61, 0xc8000
    buffer_load_dwordx4 v[40:43], v10, s[24:27], s52 offen
    s_add_u32 s52, s61, 0xd8000
    buffer_load_dwordx4 v[44:47], v10, s[24:27], s52 offen
    s_add_u32 s52, s61, 0xe8000
    buffer_load_dwordx4 v[48:51], v10, s[24:27], s52 offen
    s_add_u32 s52, s61, 0xf8000
    buffer_load_dwordx4 v[52:55], v10, s[24:27], s52 offen
    v_add_u32 v20, s60, v3
    v_add_u32 v21, 0x10000, v20
    v_add_u32 v22, 0x20000, v20
    s_waitcnt vmcnt(0)
    s_barrier
    s_add_u32 s52, s61, 0x100000
    s_add_u32 m0, s60, 0x2000
    s_nop 0
    buffer_load_dwordx4 v10, s[24:27], s52 offen lds
    ds_write_b128 v20, v[24:27] offset:0
    s_add_u32 s52, s61, 0x110000
    s_add_u32 m0, s60, 0xa000
    s_nop 0
    buffer_load_dwordx4 v10, s[24:27], s52 offen lds
    ds_write_b128 v20, v[28:31] offset:32768
    s_add_u32 s52, s61, 0x120000
    s_add_u32 m0, s60, 0x12000
    s_nop 0
    buffer_load_dwordx4 v10, s[24:27], s52 offen lds
    ds_write_b128 v21, v[32:35] offset:0
    s_add_u32 s52, s61, 0x130000
    s_add_u32 m0, s60, 0x22000
    s_nop 0
    buffer_load_dwordx4 v10, s[24:27], s52 offen lds
    ds_write_b128 v22, v[36:39] offset:0
    s_add_u32 s52, s61, 0x108000
    s_add_u32 m0, s60, 0x3000
    s_nop 0
    buffer_load_dwordx4 v10, s[24:27], s52 offen lds
    ds_write_b128 v20, v[40:43] offset:4096
    s_add_u32 s52, s61, 0x118000
    s_add_u32 m0, s60, 0xb000
    s_nop 0
    buffer_load_dwordx4 v10, s[24:27], s52 offen lds
    ds_write_b128 v20, v[44:47] offset:36864
    s_add_u32 s52, s61, 0x128000
    s_add_u32 m0, s60, 0x13000
    s_nop 0
    buffer_load_dwordx4 v10, s[24:27], s52 offen lds
    ds_write_b128 v21, v[48:51] offset:4096
    s_add_u32 s52, s61, 0x138000
    s_add_u32 m0, s60, 0x23000
    s_nop 0
    buffer_load_dwordx4 v10, s[24:27], s52 offen lds
    ds_write_b128 v22, v[52:55] offset:4096
    s_add_u32 s52, s61, 0x140000
    s_add_u32 m0, s60, 0x4000
    s_nop 0
    buffer_load_dwordx4 v10, s[24:27], s52 offen lds
    s_add_u32 s52, s61, 0x150000
    s_add_u32 m0, s60, 0xc000
    s_nop 0
    buffer_load_dwordx4 v10, s[24:27], s52 offen lds
    s_add_u32 s52, s61, 0x160000
    s_add_u32 m0, s60, 0x14000
    s_nop 0
    buffer_load_dwordx4 v10, s[24:27], s52 offen lds
    s_add_u32 s52, s61, 0x170000
    s_add_u32 m0, s60, 0x24000
    s_nop 0
    buffer_load_dwordx4 v10, s[24:27], s52 offen lds
    s_add_u32 s52, s61, 0x148000
    s_add_u32 m0, s60, 0x5000
    s_nop 0
    buffer_load_dwordx4 v10, s[24:27], s52 offen lds
    s_add_u32 s52, s61, 0x158000
    s_add_u32 m0, s60, 0xd000
    s_nop 0
    buffer_load_dwordx4 v10, s[24:27], s52 offen lds
    s_add_u32 s52, s61, 0x168000
    s_add_u32 m0, s60, 0x15000
    s_nop 0
    buffer_load_dwordx4 v10, s[24:27], s52 offen lds
    s_add_u32 s52, s61, 0x178000
    s_add_u32 m0, s60, 0x25000
    s_nop 0
    buffer_load_dwordx4 v10, s[24:27], s52 offen lds
    s_barrier
    s_cmp_lg_u32 s57, 0
    s_cbranch_scc1 fused_kernel_h0100
    s_cmp_lg_u32 s47, 0
    s_cbranch_scc1 fused_kernel_h0100
    s_lshl_b32 s50, s45, 21
    s_add_u32 s50, s50, 0x120000
    s_add_u32 s50, s50, s46
    v_mov_b32 v5, 4
    s_mov_b64 exec, 1
    buffer_store_byte v5, v14, s[40:43], s50 offen
    s_mov_b64 exec, -1
    s_mov_b64 exec, -1
fused_kernel_h0100:
    s_cmp_eq_u32 s57, 0
    s_cbranch_scc1 fused_kernel_xs102
    s_sleep 2
fused_kernel_xs102:
    s_add_u32 s52, s61, 0x80000
    s_add_u32 m0, s60, 0x6000
    s_nop 0
    buffer_load_dwordx4 v10, s[24:27], s52 offen lds
    s_add_u32 s52, s61, 0x90000
    s_add_u32 m0, s60, 0xe000
    s_nop 0
    buffer_load_dwordx4 v10, s[24:27], s52 offen lds
    s_add_u32 s52, s61, 0xa0000
    s_add_u32 m0, s60, 0x16000
    s_nop 0
    buffer_load_dwordx4 v10, s[24:27], s52 offen lds
    s_add_u32 s52, s61, 0xb0000
    s_add_u32 m0, s60, 0x26000
    s_nop 0
    buffer_load_dwordx4 v10, s[24:27], s52 offen lds
    s_add_u32 s52, s61, 0x88000
    s_add_u32 m0, s60, 0x7000
    s_nop 0
    buffer_load_dwordx4 v10, s[24:27], s52 offen lds
    s_add_u32 s52, s61, 0x98000
    s_add_u32 m0, s60, 0xf000
    s_nop 0
    buffer_load_dwordx4 v10, s[24:27], s52 offen lds
    s_add_u32 s52, s61, 0xa8000
    s_add_u32 m0, s60, 0x17000
    s_nop 0
    buffer_load_dwordx4 v10, s[24:27], s52 offen lds
    s_add_u32 s52, s61, 0xb8000
    s_add_u32 m0, s60, 0x27000
    s_nop 0
    buffer_load_dwordx4 v10, s[24:27], s52 offen lds
    s_and_b32 s50, s46, 31
    s_lshl_b32 s50, s50, 2
    s_add_u32 s50, s50, s57
    s_mul_i32 s50, s50, 2048
    s_add_u32 s50, s50, 0x180000
    s_mov_b32 exec_lo, 0xffff
    s_mov_b32 exec_hi, 0x0
    buffer_load_dword v17, v12, s[24:27], s50 offen
    s_mov_b64 exec, -1
    s_cmp_lg_u32 s57, 0
    s_cbranch_scc1 fused_kernel_h0103
    s_cmp_lg_u32 s47, 0
    s_cbranch_scc1 fused_kernel_fb104
    s_mov_b64 exec, 0xff
    s_lshl_b32 s50, s45, 21
    s_add_u32 s50, s50, 0x120000
    s_bfe_u32 s51, s46, 0x10001
    s_lshl_b32 s51, s51, 3
    s_lshl_b32 s51, 0x00800080, s51
    v_mov_b32 v15, s51
    s_mov_b32 s53, 0
fused_kernel_p0108:
    buffer_load_dword v160, v13, s[40:43], s50 offen sc1
    s_sleep 2
    buffer_load_dword v161, v13, s[40:43], s50 offen sc1
    s_sleep 2
    buffer_load_dword v162, v13, s[40:43], s50 offen sc1
fused_kernel_p105:
    s_waitcnt vmcnt(2)
    v_or_b32 v5, 0x80808080, v160
    v_subrev_u32 v5, 0x4040404, v5
    v_and_b32 v5, v5, v15
    v_cmp_ne_u32 vcc, v5, v15
    s_nop 4
    s_cbranch_vccz fused_kernel_x106
    buffer_load_dword v160, v13, s[40:43], s50 offen sc1
    s_waitcnt vmcnt(2)
    v_or_b32 v5, 0x80808080, v161
    v_subrev_u32 v5, 0x4040404, v5
    v_and_b32 v5, v5, v15
    v_cmp_ne_u32 vcc, v5, v15
    s_nop 4
    s_cbranch_vccz fused_kernel_x106
    buffer_load_dword v161, v13, s[40:43], s50 offen sc1
    s_waitcnt vmcnt(2)
    v_or_b32 v5, 0x80808080, v162
    v_subrev_u32 v5, 0x4040404, v5
    v_and_b32 v5, v5, v15
    v_cmp_ne_u32 vcc, v5, v15
    s_nop 4
    s_cbranch_vccz fused_kernel_x106
    buffer_load_dword v162, v13, s[40:43], s50 offen sc1
    s_add_u32 s53, s53, 1
    s_cmp_gt_u32 s53, 32768
    s_cbranch_scc1 fused_kernel_t107
    s_branch fused_kernel_p105
fused_kernel_t107:
    s_mov_b32 s48, 1
fused_kernel_x106:
    s_mov_b64 exec, -1
    s_branch fused_kernel_h0103
fused_kernel_fb104:
    buffer_wbl2 sc1
    s_waitcnt vmcnt(0)
    s_mov_b64 exec, 1
    v_mov_b32 v5, 1
    buffer_atomic_add v5, v14, s[36:39], 0 offen offset:152 sc1
    s_mov_b32 s53, 0
fused_kernel_gp109:
    s_sleep 8
    s_add_u32 s53, s53, 1
    s_cmp_gt_u32 s53, 32768
    s_cbranch_scc1 fused_kernel_gx110
    buffer_load_dword v5, v14, s[36:39], 0 offen offset:152 sc1
    s_waitcnt vmcnt(0)
    v_cmp_gt_u32 vcc, 256, v5
    s_nop 4
    s_cbranch_vccnz fused_kernel_gp109
fused_kernel_gx110:
    s_mov_b64 exec, -1
    buffer_inv sc1
    s_waitcnt vmcnt(0)
    s_mov_b64 exec, -1
fused_kernel_h0103:
    s_waitcnt lgkmcnt(0)
    s_waitcnt vmcnt(1)
    s_barrier
    s_endpgm
fused_kernel_hfallback:
    s_mov_b32 s47, 1
    s_mov_b32 s48, 0
    s_waitcnt vmcnt(0) lgkmcnt(0)
    s_barrier
    s_cmp_lg_u32 s57, 0
    s_cbranch_scc1 fused_kernel_h0111
    buffer_wbl2 sc1
    s_waitcnt vmcnt(0)
    s_mov_b64 exec, 1
    v_mov_b32 v5, 1
    buffer_atomic_add v5, v14, s[36:39], 0 offen offset:156 sc1
    s_mov_b32 s53, 0
fused_kernel_gp112:
    s_sleep 8
    s_add_u32 s53, s53, 1
    s_cmp_gt_u32 s53, 32768
    s_cbranch_scc1 fused_kernel_gx113
    buffer_load_dword v5, v14, s[36:39], 0 offen offset:156 sc1
    s_waitcnt vmcnt(0)
    v_cmp_gt_u32 vcc, 256, v5
    s_nop 4
    s_cbranch_vccnz fused_kernel_gp112
fused_kernel_gx113:
    s_mov_b64 exec, -1
    buffer_inv sc1
    s_waitcnt vmcnt(0)
    s_mov_b64 exec, -1
fused_kernel_h0111:
    s_barrier
    s_branch fused_kernel_hstart
fused_kernel_done:
    s_endpgm
.section .rodata,"a"
.p2align 6
.amdhsa_kernel fused_kernel
  .amdhsa_next_free_vgpr 168
  .amdhsa_next_free_sgpr 80
  .amdhsa_accum_offset 168
  .amdhsa_group_segment_fixed_size 0
  .amdhsa_kernarg_size 88
  .amdhsa_user_sgpr_count 2
  .amdhsa_user_sgpr_kernarg_segment_ptr 1
  .amdhsa_system_sgpr_workgroup_id_x 1
  .amdhsa_float_denorm_mode_32 3
  .amdhsa_float_denorm_mode_16_64 3
.end_amdhsa_kernel
```
